```python
import torch

def _softmax(x, axis=-1):
    return torch.softmax(x, dim=axis)

def _gelu(x):
    return torch.nn.functional.gelu(x, approximate='tanh')

def _silu(x):
    return torch.nn.functional.silu(x)

def _sigmoid(x):
    return torch.sigmoid(x)

def _layernorm(x, axis=-1, eps=1e-05):
    m = x.mean(dim=axis, keepdim=True)
    v = x.var(dim=axis, keepdim=True, unbiased=False)
    return (x - m) / torch.sqrt(v + eps)

def _scatter_add(tgt, idx, src, axis=0):
    return tgt.clone().index_add_(axis, idx, src)

def _segment_sum(src, seg, n):
    out = torch.zeros((n,) + src.shape[1:], dtype=src.dtype)
    return out.index_add_(0, seg, src)

def _pad(x, pw):
    flat = tuple((v for pair in reversed(pw) for v in pair))
    return torch.nn.functional.pad(x, flat)
kernel_name = 'standalone__transposed_strided__vision'

def setup_inputs():

    _w = lambda a: (lambda t: t.to(torch.bfloat16) if t.is_floating_point() else t)(torch.as_tensor(a))
    H = W = 224
    C = 96
    return {'x': _w((lambda *s: torch.randn(*s, dtype=torch.bfloat16) * 0.05)(1, H, W, C)), 'w': _w((lambda *s: torch.randn(*s, dtype=torch.bfloat16) * 0.05)(4, 4, C, C)), 'b': _w((lambda *s: torch.randn(*s, dtype=torch.bfloat16) * 0.05)(C))}

def reference(x, w, b):
    B, H, W, C = x.shape
    s, k = (2, 4)
    xe = x[:, :, None, :, None, :].clone()
    xz = _pad(xe, ((0, 0), (0, 0), (0, s - 1), (0, 0), (0, s - 1), (0, 0)))
    xz = xz.reshape(B, H * s, W * s, C)[:, :(H - 1) * s + 1, :(W - 1) * s + 1, :]
    xp = _pad(xz, ((0, 0), (k - 1, k - 1), (k - 1, k - 1), (0, 0)))
    Ho, Wo = ((H - 1) * s + k, (W - 1) * s + k)
    out = 0
    for i in range(k):
        for j in range(k):
            out = out + torch.einsum('bhwc,cd->bhwd', xp[:, i:i + Ho, j:j + Wo, :], w[k - 1 - i, k - 1 - j])
    return out[:, 1:-1, 1:-1, :] + b
```

```asm
; @launch grid=(256,1,1) block=(256,1,1) lds=155904
.amdgcn_target "amdgcn-amd-amdhsa--gfx950"
.text
.globl standalone__transposed_strided__vision_kernel
.p2align 8
.type standalone__transposed_strided__vision_kernel,@function
standalone__transposed_strided__vision_kernel:
    s_cmp_ge_u32 s2, 256
    s_cbranch_scc1 L_end
    s_load_dwordx4 s[4:7], s[0:1], 0
    s_load_dwordx4 s[8:11], s[0:1], 16
    v_lshrrev_b32 v4, 6, v0
    s_getpc_b64 s[66:67]
L_pc:
    v_readfirstlane_b32 s32, v4
    v_and_b32 v0, 63, v0
    s_lshr_b32 s98, s2, 3
    s_lshl2_add_u32 s98, s98, s32
    s_lshl_b32 s41, s98, 7
    v_lshrrev_b32 v1, 5, v0
    v_lshlrev_b32 v1, 14, v1
    v_add_u32 v1, s41, v1
    v_min_u32 v1, L_codeend-L_pc-4, v1
    v_mov_b32 v31, s67
    v_add_co_u32 v30, vcc, s66, v1
    s_and_b32 s41, s2, 7
    s_lshl_b32 s41, s41, 2
    s_or_b32 s41, s41, 0x30000
    s_bfe_u32 s41, 0x37652104, s41
    s_lshr_b32 s42, s2, 5
    v_addc_co_u32 v31, vcc, 0, v31, vcc
    global_load_dword v6, v[30:31], off
    s_mul_i32 s43, s41, 7
    s_add_u32 s43, s43, s42
    s_add_u32 s44, s41, 60
    s_cmp_eq_u32 s42, 7
    s_cselect_b32 s43, s44, s43
    s_lshl3_add_u32 s44, s41, s42
    s_sub_u32 s44, s44, 4
    s_cmp_lt_u32 s41, 4
    s_cselect_b32 s42, s43, s44
    s_cmp_ge_u32 s42, 63
    s_cbranch_scc1 L_end
    s_bfe_u32 s35, s2, 0x10003
    s_bfe_u32 s36, s2, 0x10004
    s_lshl2_add_u32 s42, s42, s32
    s_mul_i32 s38, s42, 4682
    s_lshr_b32 s38, s38, 16
    s_mul_i32 s41, s38, 14
    s_sub_u32 s37, s42, s41
    s_min_u32 s41, s38, 8
    s_mul_i32 s39, s38, 12
    s_add_u32 s39, s39, s41
    v_mul_u32_u24 v24, 9363, v0
    s_lshl1_add_u32 s41, s36, s35
    v_lshrrev_b32 v24, 16, v24
    s_mul_i32 s41, s41, 7
    v_mul_u32_u24 v5, 7, v24
    s_mul_i32 s42, s37, 24
    v_sub_u32 v5, v0, v5
    s_add_u32 s41, s41, s42
    s_sub_u32 s41, s41, 2
    v_add_u32 v5, s41, v5
    v_max_i32 v5, 0, v5
    v_lshlrev_b32 v25, 7, v5
    s_movk_i32 s96, 223
    s_mov_b32 s97, 43008
    s_add_i32 s42, s39, -1
    v_add_u32 v5, s42, v24
    v_med3_i32 v5, v5, 0, s96
    v_mad_u32_u24 v22, v5, s97, v25
    s_mul_i32 s41, s98, 2304
    v_lshlrev_b32 v4, 7, v0
    v_add_u32 v21, s41, v4
    s_mov_b32 s14, 9633792
    s_mov_b32 s15, 0x20000
    s_mov_b32 s22, 294912
    s_mov_b32 s23, 0x20000
    s_waitcnt lgkmcnt(0)
    s_mov_b32 s12, s4
    s_and_b32 s13, s5, 0xffff
    s_mov_b32 s20, s6
    s_and_b32 s21, s7, 0xffff
    s_mov_b32 exec_lo, 0xfffffff
    s_mov_b32 exec_hi, 0x0
    buffer_load_dword v6, v22, s[12:15], 0 offen
    s_mov_b64 exec, -1
    s_mov_b32 exec_lo, 0x3ffff
    s_mov_b32 exec_hi, 0x0
    buffer_load_dword v6, v21, s[20:23], 0 offen
    s_mov_b64 exec, -1
    s_mov_b32 s16, s4
    s_and_b32 s17, s5, 0xffff
    s_mov_b32 s19, 0x20000
    s_mov_b32 s24, s8
    s_and_b32 s25, s9, 0xffff
    s_mov_b32 s26, 192
    s_mov_b32 s27, 0x20000
    s_mov_b32 s28, s10
    s_and_b32 s29, s11, 0xffff
    s_mov_b32 s30, 38535168
    s_mov_b32 s31, 0x20000
    s_add_u32 s46, s39, s36
    s_sub_u32 s46, s46, 1
    s_mul_i32 s45, s46, 43008
    s_lshl4_add_u32 s41, s37, s35
    s_sub_u32 s42, s41, 1
    s_mulk_i32 s42, 192
    s_cmp_eq_u32 s41, 0
    s_cselect_b32 s43, 12, 0
    s_cmpk_gt_u32 s41, 208
    s_cselect_b32 s44, 0, 12
    s_mov_b32 s60, 0
    s_mov_b32 s61, 0xffff0000
    s_mov_b32 s62, -1
    s_mov_b32 s63, 0
    s_mov_b32 s64, 0xffff0000
    s_mov_b32 s65, -1
    v_lshlrev_b32 v11, 4, v0
    v_xor_b32 v1, 32, v11
    v_add_u32 v1, s42, v1
    v_add_u32 v10, s42, v11
    v_bfrev_b32 v3, 1
    v_cmp_gt_u32 vcc, s43, v0
    v_cndmask_b32 v7, v10, v1, s[60:61]
    v_cndmask_b32 v8, v10, v1, s[62:63]
    v_cndmask_b32 v7, v7, v3, vcc
    v_cmp_le_u32 vcc, s44, v0
    v_cndmask_b32 v9, v10, v1, s[64:65]
    v_lshrrev_b32 v2, 5, v0
    v_cndmask_b32 v10, v10, v3, vcc
    v_mul_u32_u24 v2, 1536, v2
    v_add_u32 v12, v11, v2
    v_add_u32 v13, 1536, v11
    s_lshr_b32 s33, s32, 1
    s_and_b32 s34, s32, 1
    s_lshl2_add_u32 s41, s36, s35
    s_sub_u32 s41, 5, s41
    s_mul_i32 s48, s41, 18432
    s_mul_i32 s41, s34, 1536
    s_add_u32 s48, s48, s41
    s_mul_i32 s43, s34, 3080
    s_mul_i32 s44, s33, 6160
    s_add_u32 s49, s43, s44
    s_mul_i32 s47, s32, 20480
    s_add_u32 s47, s47, 73984
    v_lshrrev_b32 v2, 4, v0
    v_and_b32 v3, 15, v0
    v_lshlrev_b32 v19, 4, v2
    v_add_u32 v4, 1, v3
    v_mul_u32_u24 v5, 192, v4
    v_add_u32 v5, v5, v19
    v_lshlrev_b32 v4, 3, v4
    v_and_b32 v4, 32, v4
    v_xor_b32 v5, v5, v4
    v_add_u32 v14, s47, v5
    v_add_u32 v4, 0, v3
    v_mul_u32_u24 v5, 192, v4
    v_add_u32 v5, v5, v19
    v_lshlrev_b32 v4, 3, v4
    v_and_b32 v4, 32, v4
    v_xor_b32 v5, v5, v4
    v_add_u32 v15, s47, v5
    v_and_b32 v4, 1, v2
    v_mul_u32_u24 v4, 3080, v4
    v_lshrrev_b32 v5, 1, v2
    v_mul_u32_u24 v5, 1536, v5
    v_add_u32 v4, v4, v5
    v_lshrrev_b32 v5, 2, v3
    v_mul_u32_u24 v5, 192, v5
    v_add_u32 v4, v4, v5
    v_and_b32 v5, 3, v3
    v_lshlrev_b32 v5, 4, v5
    v_add_u32 v16, v4, v5
    v_add_u32 v17, 36960, v16
    s_add_i32 s42, s39, 5
    v_add_u32 v5, s42, v24
    v_med3_i32 v5, v5, 0, s96
    v_mad_u32_u24 v23, v5, s97, v25
    s_lshl1_add_u32 s41, s39, s36
    s_mulk_i32 s41, 448
    s_lshl_b32 s42, s37, 5
    s_add_u32 s41, s41, s42
    s_add_u32 s41, s41, s35
    s_mul_i32 s92, s41, 192
    s_add_u32 s93, s92, 172032
    s_add_u32 s94, s93, 172032
    s_add_u32 s57, s92, 172032
    s_cmp_lt_u32 s38, 8
    s_cselect_b32 s40, 13, 12
    s_mul_i32 s41, s32, 9216
    v_lshrrev_b32 v4, 1, v3
    v_and_b32 v4, 3, v4
    v_xor_b32 v4, v4, v2
    v_lshlrev_b32 v4, 4, v4
    v_lshlrev_b32 v5, 6, v3
    v_add3_u32 v30, v4, v5, s41
    v_lshrrev_b32 v1, 2, v0
    v_and_b32 v4, 3, v0
    v_mul_u32_u24 v5, 384, v1
    v_lshl_add_u32 v20, v4, 4, v5
    v_bfe_u32 v5, v1, 1, 2
    v_xor_b32 v4, v4, v5
    v_lshlrev_b32 v4, 4, v4
    v_lshlrev_b32 v5, 6, v1
    v_add3_u32 v31, v4, v5, s41
    v_mul_u32_u24 v4, 384, v3
    v_add_u32 v18, v4, v19
    s_nop 0
    buffer_load_dwordx4 v[104:107], v19, s[24:27], 0 offen offset:0
    buffer_load_dwordx4 v[108:111], v19, s[24:27], 0 offen offset:64
    buffer_load_dwordx4 v[112:115], v19, s[24:27], 0 offen offset:128
    s_cmp_eq_u32 s33, 0
    s_mov_b32 s41, 153600
    s_cselect_b32 s41, 147456, s41
    s_add_u32 s50, s41, s48
    s_add_u32 m0, s49, 0
    s_nop 0
    buffer_load_dwordx4 v11, s[20:23], s50 offen lds
    buffer_load_dwordx4 v12, s[20:23], s50 offen offset:1024 lds
    buffer_load_dwordx4 v13, s[20:23], s50 offen offset:2048 lds
    s_cmp_lt_u32 s46, 224
    s_cselect_b32 s18, 9633792, 0
    s_add_u32 m0, s47, 0
    s_nop 0
    buffer_load_dwordx4 v7, s[16:19], s45 offen lds
    buffer_load_dwordx4 v8, s[16:19], s45 offen offset:1024 lds
    buffer_load_dwordx4 v9, s[16:19], s45 offen offset:2048 lds
    s_mov_b64 exec, 0xfff
    buffer_load_dwordx4 v10, s[16:19], s45 offen offset:3072 lds
    s_mov_b64 exec, -1
    s_add_u32 s45, s45, 43008
    s_add_u32 s46, s46, 1
    s_add_u32 m0, s47, 4096
    s_nop 0
    buffer_load_dwordx4 v7, s[12:15], s45 offen lds
    buffer_load_dwordx4 v8, s[12:15], s45 offen offset:1024 lds
    buffer_load_dwordx4 v9, s[12:15], s45 offen offset:2048 lds
    s_mov_b64 exec, 0xfff
    buffer_load_dwordx4 v10, s[12:15], s45 offen offset:3072 lds
    s_mov_b64 exec, -1
    s_add_u32 s45, s45, 43008
    s_add_u32 s46, s46, 1
    s_cmp_eq_u32 s33, 0
    s_mov_b32 s41, 184320
    s_cselect_b32 s41, 159744, s41
    s_add_u32 s51, s41, s48
    s_add_u32 m0, s49, 12320
    s_nop 0
    buffer_load_dwordx4 v11, s[20:23], s51 offen lds
    buffer_load_dwordx4 v12, s[20:23], s51 offen offset:1024 lds
    buffer_load_dwordx4 v13, s[20:23], s51 offen offset:2048 lds
    s_cmp_eq_u32 s33, 0
    s_mov_b32 s41, 196608
    s_cselect_b32 s41, 190464, s41
    s_add_u32 s52, s41, s48
    s_add_u32 m0, s49, 24640
    s_nop 0
    buffer_load_dwordx4 v11, s[20:23], s52 offen lds
    buffer_load_dwordx4 v12, s[20:23], s52 offen offset:1024 lds
    buffer_load_dwordx4 v13, s[20:23], s52 offen offset:2048 lds
    s_add_u32 m0, s47, 8192
    s_nop 0
    buffer_load_dwordx4 v7, s[12:15], s45 offen lds
    buffer_load_dwordx4 v8, s[12:15], s45 offen offset:1024 lds
    buffer_load_dwordx4 v9, s[12:15], s45 offen offset:2048 lds
    s_mov_b64 exec, 0xfff
    buffer_load_dwordx4 v10, s[12:15], s45 offen offset:3072 lds
    s_mov_b64 exec, -1
    s_add_u32 s45, s45, 43008
    s_add_u32 s46, s46, 1
    s_cmp_eq_u32 s33, 0
    s_mov_b32 s41, 6144
    s_cselect_b32 s41, 0, s41
    s_add_u32 s53, s41, s48
    s_add_u32 m0, s49, 36960
    s_nop 0
    buffer_load_dwordx4 v11, s[20:23], s53 offen lds
    buffer_load_dwordx4 v12, s[20:23], s53 offen offset:1024 lds
    buffer_load_dwordx4 v13, s[20:23], s53 offen offset:2048 lds
    s_waitcnt vmcnt(24)
    v_lshlrev_b32 v160, 16, v104
    v_and_b32 v161, 0xffff0000, v104
    v_lshlrev_b32 v162, 16, v105
    v_and_b32 v163, 0xffff0000, v105
    v_lshlrev_b32 v164, 16, v106
    v_and_b32 v165, 0xffff0000, v106
    v_lshlrev_b32 v166, 16, v107
    v_and_b32 v167, 0xffff0000, v107
    v_lshlrev_b32 v168, 16, v108
    v_and_b32 v169, 0xffff0000, v108
    v_lshlrev_b32 v170, 16, v109
    v_and_b32 v171, 0xffff0000, v109
    v_lshlrev_b32 v172, 16, v110
    v_and_b32 v173, 0xffff0000, v110
    v_lshlrev_b32 v174, 16, v111
    v_and_b32 v175, 0xffff0000, v111
    v_lshlrev_b32 v176, 16, v112
    v_and_b32 v177, 0xffff0000, v112
    v_lshlrev_b32 v178, 16, v113
    v_and_b32 v179, 0xffff0000, v113
    v_lshlrev_b32 v180, 16, v114
    v_and_b32 v181, 0xffff0000, v114
    v_lshlrev_b32 v182, 16, v115
    v_and_b32 v183, 0xffff0000, v115
    s_waitcnt vmcnt(17)
    ds_read_b128 v[32:35], v14 offset:0
    ds_read_b128 v[36:39], v14 offset:64
    ds_read_b128 v[40:43], v14 offset:128
    ds_read_b128 v[44:47], v15 offset:0
    ds_read_b128 v[48:51], v15 offset:64
    ds_read_b128 v[52:55], v15 offset:128
    s_waitcnt vmcnt(13)
    ds_read_b128 v[56:59], v14 offset:4096
    ds_read_b128 v[60:63], v14 offset:4160
    ds_read_b128 v[64:67], v14 offset:4224
    ds_read_b128 v[68:71], v15 offset:4096
    ds_read_b128 v[72:75], v15 offset:4160
    ds_read_b128 v[76:79], v15 offset:4224
    s_barrier
    s_waitcnt lgkmcnt(0)
    ds_read_b64_tr_b16 a[0:1], v16 offset:0
    ds_read_b64_tr_b16 a[2:3], v16 offset:768
    ds_read_b64_tr_b16 a[4:5], v16 offset:8
    ds_read_b64_tr_b16 a[6:7], v16 offset:776
    ds_read_b64_tr_b16 a[8:9], v16 offset:64
    ds_read_b64_tr_b16 a[10:11], v16 offset:832
    ds_read_b64_tr_b16 a[12:13], v16 offset:72
    ds_read_b64_tr_b16 a[14:15], v16 offset:840
    ds_read_b64_tr_b16 a[16:17], v16 offset:128
    ds_read_b64_tr_b16 a[18:19], v16 offset:896
    s_waitcnt lgkmcnt(8)
    v_mfma_f32_16x16x32_bf16 v[104:107], a[0:3], v[32:35], v[160:163]
    ds_read_b64_tr_b16 a[20:21], v16 offset:136
    s_cmp_eq_u32 s33, 0
    s_mov_b32 s41, 36864
    s_cselect_b32 s41, 12288, s41
    s_add_u32 s54, s41, s48
    s_add_u32 m0, s49, 49280
    v_mfma_f32_16x16x32_bf16 v[128:131], a[0:3], v[56:59], v[160:163]
    ds_read_b64_tr_b16 a[22:23], v16 offset:904
    buffer_load_dwordx4 v11, s[20:23], s54 offen lds
    s_waitcnt lgkmcnt(8)
    v_mfma_f32_16x16x32_bf16 v[108:111], a[4:7], v[32:35], v[164:167]
    ds_read_b64_tr_b16 a[24:25], v16 offset:6160
    v_mfma_f32_16x16x32_bf16 v[132:135], a[4:7], v[56:59], v[164:167]
    ds_read_b64_tr_b16 a[26:27], v16 offset:6928
    buffer_load_dwordx4 v12, s[20:23], s54 offen offset:1024 lds
    s_waitcnt lgkmcnt(8)
    v_mfma_f32_16x16x32_bf16 v[112:115], a[8:11], v[32:35], v[168:171]
    ds_read_b64_tr_b16 a[28:29], v16 offset:6168
    v_mfma_f32_16x16x32_bf16 v[136:139], a[8:11], v[56:59], v[168:171]
    ds_read_b64_tr_b16 a[30:31], v16 offset:6936
    buffer_load_dwordx4 v13, s[20:23], s54 offen offset:2048 lds
    s_waitcnt lgkmcnt(8)
    v_mfma_f32_16x16x32_bf16 v[116:119], a[12:15], v[32:35], v[172:175]
    ds_read_b64_tr_b16 a[32:33], v16 offset:6224
    s_cmp_eq_u32 s33, 0
    s_mov_b32 s41, 49152
    s_cselect_b32 s41, 43008, s41
    s_add_u32 s55, s41, s48
    s_add_u32 m0, s49, 61600
    v_mfma_f32_16x16x32_bf16 v[140:143], a[12:15], v[56:59], v[172:175]
    ds_read_b64_tr_b16 a[34:35], v16 offset:6992
    buffer_load_dwordx4 v11, s[20:23], s55 offen lds
    s_waitcnt lgkmcnt(8)
    v_mfma_f32_16x16x32_bf16 v[120:123], a[16:19], v[32:35], v[176:179]
    ds_read_b64_tr_b16 a[36:37], v16 offset:6232
    v_mfma_f32_16x16x32_bf16 v[144:147], a[16:19], v[56:59], v[176:179]
    ds_read_b64_tr_b16 a[38:39], v16 offset:7000
    buffer_load_dwordx4 v12, s[20:23], s55 offen offset:1024 lds
    s_waitcnt lgkmcnt(8)
    v_mfma_f32_16x16x32_bf16 v[124:127], a[20:23], v[32:35], v[180:183]
    ds_read_b64_tr_b16 a[40:41], v16 offset:6288
    v_mfma_f32_16x16x32_bf16 v[148:151], a[20:23], v[56:59], v[180:183]
    ds_read_b64_tr_b16 a[42:43], v16 offset:7056
    buffer_load_dwordx4 v13, s[20:23], s55 offen offset:2048 lds
    s_waitcnt lgkmcnt(8)
    v_mfma_f32_16x16x32_bf16 v[104:107], a[24:27], v[36:39], v[104:107]
    ds_read_b64_tr_b16 a[44:45], v16 offset:6296
    s_add_u32 m0, s47, 12288
    v_mfma_f32_16x16x32_bf16 v[128:131], a[24:27], v[60:63], v[128:131]
    ds_read_b64_tr_b16 a[46:47], v16 offset:7064
    buffer_load_dwordx4 v7, s[12:15], s45 offen lds
    s_waitcnt lgkmcnt(8)
    v_mfma_f32_16x16x32_bf16 v[108:111], a[28:31], v[36:39], v[108:111]
    s_waitcnt vmcnt(17)
    s_barrier
    ds_read_b64_tr_b16 a[48:49], v16 offset:12320
    v_mfma_f32_16x16x32_bf16 v[132:135], a[28:31], v[60:63], v[132:135]
    ds_read_b64_tr_b16 a[50:51], v16 offset:13088
    buffer_load_dwordx4 v8, s[12:15], s45 offen offset:1024 lds
    s_waitcnt lgkmcnt(8)
    v_mfma_f32_16x16x32_bf16 v[112:115], a[32:35], v[36:39], v[112:115]
    ds_read_b64_tr_b16 a[52:53], v16 offset:12328
    v_mfma_f32_16x16x32_bf16 v[136:139], a[32:35], v[60:63], v[136:139]
    ds_read_b64_tr_b16 a[54:55], v16 offset:13096
    buffer_load_dwordx4 v9, s[12:15], s45 offen offset:2048 lds
    s_waitcnt lgkmcnt(8)
    v_mfma_f32_16x16x32_bf16 v[116:119], a[36:39], v[36:39], v[116:119]
    ds_read_b64_tr_b16 a[56:57], v16 offset:12384
    v_mfma_f32_16x16x32_bf16 v[140:143], a[36:39], v[60:63], v[140:143]
    ds_read_b64_tr_b16 a[58:59], v16 offset:13152
    s_mov_b64 exec, 0xfff
    buffer_load_dwordx4 v10, s[12:15], s45 offen offset:3072 lds
    s_mov_b64 exec, -1
    s_add_u32 s45, s45, 43008
    s_add_u32 s46, s46, 1
    s_waitcnt lgkmcnt(8)
    v_mfma_f32_16x16x32_bf16 v[120:123], a[40:43], v[36:39], v[120:123]
    ds_read_b64_tr_b16 a[60:61], v16 offset:12392
    s_add_u32 m0, s47, 16384
    v_mfma_f32_16x16x32_bf16 v[144:147], a[40:43], v[60:63], v[144:147]
    ds_read_b64_tr_b16 a[62:63], v16 offset:13160
    buffer_load_dwordx4 v7, s[12:15], s45 offen lds
    s_waitcnt lgkmcnt(8)
    v_mfma_f32_16x16x32_bf16 v[124:127], a[44:47], v[36:39], v[124:127]
    ds_read_b64_tr_b16 a[64:65], v16 offset:12448
    v_mfma_f32_16x16x32_bf16 v[148:151], a[44:47], v[60:63], v[148:151]
    ds_read_b64_tr_b16 a[66:67], v16 offset:13216
    buffer_load_dwordx4 v8, s[12:15], s45 offen offset:1024 lds
    s_waitcnt lgkmcnt(8)
    v_mfma_f32_16x16x32_bf16 v[104:107], a[48:51], v[40:43], v[104:107]
    ds_read_b64_tr_b16 a[68:69], v16 offset:12456
    v_mfma_f32_16x16x32_bf16 v[128:131], a[48:51], v[64:67], v[128:131]
    ds_read_b64_tr_b16 a[70:71], v16 offset:13224
    buffer_load_dwordx4 v9, s[12:15], s45 offen offset:2048 lds
    s_waitcnt lgkmcnt(8)
    v_mfma_f32_16x16x32_bf16 v[108:111], a[52:55], v[40:43], v[108:111]
    ds_read_b64_tr_b16 a[72:73], v16 offset:18480
    v_mfma_f32_16x16x32_bf16 v[132:135], a[52:55], v[64:67], v[132:135]
    ds_read_b64_tr_b16 a[74:75], v16 offset:19248
    s_mov_b64 exec, 0xfff
    buffer_load_dwordx4 v10, s[12:15], s45 offen offset:3072 lds
    s_mov_b64 exec, -1
    s_add_u32 s45, s45, 43008
    s_add_u32 s46, s46, 1
    s_waitcnt lgkmcnt(8)
    v_mfma_f32_16x16x32_bf16 v[112:115], a[56:59], v[40:43], v[112:115]
    ds_read_b64_tr_b16 a[76:77], v16 offset:18488
    v_mfma_f32_16x16x32_bf16 v[136:139], a[56:59], v[64:67], v[136:139]
    ds_read_b64_tr_b16 a[78:79], v16 offset:19256
    s_mov_b32 exec_lo, 0xffffffff
    s_mov_b32 exec_hi, 0x7fffffff
    buffer_load_dword v6, v23, s[12:15], 0 offen
    s_mov_b64 exec, -1
    s_waitcnt lgkmcnt(8)
    v_mfma_f32_16x16x32_bf16 v[116:119], a[60:63], v[40:43], v[116:119]
    ds_read_b64_tr_b16 a[80:81], v16 offset:18544
    v_mfma_f32_16x16x32_bf16 v[140:143], a[60:63], v[64:67], v[140:143]
    ds_read_b64_tr_b16 a[82:83], v16 offset:19312
    s_waitcnt lgkmcnt(8)
    v_mfma_f32_16x16x32_bf16 v[120:123], a[64:67], v[40:43], v[120:123]
    ds_read_b64_tr_b16 a[84:85], v16 offset:18552
    v_mfma_f32_16x16x32_bf16 v[144:147], a[64:67], v[64:67], v[144:147]
    ds_read_b64_tr_b16 a[86:87], v16 offset:19320
    s_waitcnt lgkmcnt(8)
    v_mfma_f32_16x16x32_bf16 v[124:127], a[68:71], v[40:43], v[124:127]
    ds_read_b64_tr_b16 a[88:89], v16 offset:18608
    v_mfma_f32_16x16x32_bf16 v[148:151], a[68:71], v[64:67], v[148:151]
    ds_read_b64_tr_b16 a[90:91], v16 offset:19376
    s_waitcnt lgkmcnt(8)
    v_mfma_f32_16x16x32_bf16 v[104:107], a[72:75], v[44:47], v[104:107]
    ds_read_b64_tr_b16 a[92:93], v16 offset:18616
    v_mfma_f32_16x16x32_bf16 v[128:131], a[72:75], v[68:71], v[128:131]
    ds_read_b64_tr_b16 a[94:95], v16 offset:19384
    s_waitcnt lgkmcnt(8)
    v_mfma_f32_16x16x32_bf16 v[108:111], a[76:79], v[44:47], v[108:111]
    s_waitcnt vmcnt(22)
    s_barrier
    ds_read_b64_tr_b16 a[96:97], v16 offset:24640
    v_mfma_f32_16x16x32_bf16 v[132:135], a[76:79], v[68:71], v[132:135]
    ds_read_b64_tr_b16 a[98:99], v16 offset:25408
    s_waitcnt lgkmcnt(8)
    v_mfma_f32_16x16x32_bf16 v[112:115], a[80:83], v[44:47], v[112:115]
    ds_read_b64_tr_b16 a[100:101], v16 offset:24648
    v_mfma_f32_16x16x32_bf16 v[136:139], a[80:83], v[68:71], v[136:139]
    ds_read_b64_tr_b16 a[102:103], v16 offset:25416
    s_waitcnt lgkmcnt(8)
    v_mfma_f32_16x16x32_bf16 v[116:119], a[84:87], v[44:47], v[116:119]
    ds_read_b64_tr_b16 a[104:105], v16 offset:24704
    v_mfma_f32_16x16x32_bf16 v[140:143], a[84:87], v[68:71], v[140:143]
    ds_read_b64_tr_b16 a[106:107], v16 offset:25472
    s_waitcnt lgkmcnt(8)
    v_mfma_f32_16x16x32_bf16 v[120:123], a[88:91], v[44:47], v[120:123]
    ds_read_b64_tr_b16 a[108:109], v16 offset:24712
    v_mfma_f32_16x16x32_bf16 v[144:147], a[88:91], v[68:71], v[144:147]
    ds_read_b64_tr_b16 a[110:111], v16 offset:25480
    s_waitcnt lgkmcnt(8)
    v_mfma_f32_16x16x32_bf16 v[124:127], a[92:95], v[44:47], v[124:127]
    ds_read_b64_tr_b16 a[112:113], v16 offset:24768
    v_mfma_f32_16x16x32_bf16 v[148:151], a[92:95], v[68:71], v[148:151]
    ds_read_b64_tr_b16 a[114:115], v16 offset:25536
    s_waitcnt lgkmcnt(8)
    v_mfma_f32_16x16x32_bf16 v[104:107], a[96:99], v[48:51], v[104:107]
    ds_read_b64_tr_b16 a[116:117], v16 offset:24776
    v_mfma_f32_16x16x32_bf16 v[128:131], a[96:99], v[72:75], v[128:131]
    ds_read_b64_tr_b16 a[118:119], v16 offset:25544
    s_waitcnt lgkmcnt(8)
    v_mfma_f32_16x16x32_bf16 v[108:111], a[100:103], v[48:51], v[108:111]
    ds_read_b64_tr_b16 a[120:121], v16 offset:30800
    v_mfma_f32_16x16x32_bf16 v[132:135], a[100:103], v[72:75], v[132:135]
    ds_read_b64_tr_b16 a[122:123], v16 offset:31568
    s_waitcnt lgkmcnt(8)
    v_mfma_f32_16x16x32_bf16 v[112:115], a[104:107], v[48:51], v[112:115]
    ds_read_b64_tr_b16 a[124:125], v16 offset:30808
    v_mfma_f32_16x16x32_bf16 v[136:139], a[104:107], v[72:75], v[136:139]
    ds_read_b64_tr_b16 a[126:127], v16 offset:31576
    s_waitcnt lgkmcnt(8)
    v_mfma_f32_16x16x32_bf16 v[116:119], a[108:111], v[48:51], v[116:119]
    ds_read_b64_tr_b16 a[128:129], v16 offset:30864
    v_mfma_f32_16x16x32_bf16 v[140:143], a[108:111], v[72:75], v[140:143]
    ds_read_b64_tr_b16 a[130:131], v16 offset:31632
    s_waitcnt lgkmcnt(8)
    v_mfma_f32_16x16x32_bf16 v[120:123], a[112:115], v[48:51], v[120:123]
    ds_read_b64_tr_b16 a[132:133], v16 offset:30872
    v_mfma_f32_16x16x32_bf16 v[144:147], a[112:115], v[72:75], v[144:147]
    ds_read_b64_tr_b16 a[134:135], v16 offset:31640
    s_waitcnt lgkmcnt(8)
    v_mfma_f32_16x16x32_bf16 v[124:127], a[116:119], v[48:51], v[124:127]
    ds_read_b64_tr_b16 a[136:137], v16 offset:30928
    s_waitcnt vmcnt(18)
    v_mfma_f32_16x16x32_bf16 v[148:151], a[116:119], v[72:75], v[148:151]
    ds_read_b64_tr_b16 a[138:139], v16 offset:31696
    s_waitcnt lgkmcnt(8)
    v_mfma_f32_16x16x32_bf16 v[104:107], a[120:123], v[52:55], v[104:107]
    ds_read_b64_tr_b16 a[140:141], v16 offset:30936
    v_mfma_f32_16x16x32_bf16 v[128:131], a[120:123], v[76:79], v[128:131]
    ds_read_b64_tr_b16 a[142:143], v16 offset:31704
    ds_read_b128 v[80:83], v14 offset:8192
    s_waitcnt lgkmcnt(9)
    v_mfma_f32_16x16x32_bf16 v[108:111], a[124:127], v[52:55], v[108:111]
    s_waitcnt vmcnt(15)
    s_barrier
    ds_read_b64_tr_b16 a[144:145], v17 offset:0
    v_mfma_f32_16x16x32_bf16 v[132:135], a[124:127], v[76:79], v[132:135]
    ds_read_b64_tr_b16 a[146:147], v17 offset:768
    ds_read_b128 v[84:87], v14 offset:8256
    s_waitcnt lgkmcnt(10)
    v_mfma_f32_16x16x32_bf16 v[112:115], a[128:131], v[52:55], v[112:115]
    ds_read_b64_tr_b16 a[148:149], v17 offset:8
    v_mfma_f32_16x16x32_bf16 v[136:139], a[128:131], v[76:79], v[136:139]
    ds_read_b64_tr_b16 a[150:151], v17 offset:776
    ds_read_b128 v[88:91], v14 offset:8320
    s_waitcnt lgkmcnt(11)
    v_mfma_f32_16x16x32_bf16 v[116:119], a[132:135], v[52:55], v[116:119]
    ds_read_b64_tr_b16 a[152:153], v17 offset:64
    v_mfma_f32_16x16x32_bf16 v[140:143], a[132:135], v[76:79], v[140:143]
    ds_read_b64_tr_b16 a[154:155], v17 offset:832
    ds_read_b128 v[92:95], v15 offset:8192
    s_waitcnt lgkmcnt(12)
    v_mfma_f32_16x16x32_bf16 v[120:123], a[136:139], v[52:55], v[120:123]
    ds_read_b64_tr_b16 a[156:157], v17 offset:72
    v_mfma_f32_16x16x32_bf16 v[144:147], a[136:139], v[76:79], v[144:147]
    ds_read_b64_tr_b16 a[158:159], v17 offset:840
    ds_read_b128 v[96:99], v15 offset:8256
    s_waitcnt lgkmcnt(13)
    v_mfma_f32_16x16x32_bf16 v[124:127], a[140:143], v[52:55], v[124:127]
    ds_read_b64_tr_b16 a[160:161], v17 offset:128
    v_mfma_f32_16x16x32_bf16 v[148:151], a[140:143], v[76:79], v[148:151]
    ds_read_b64_tr_b16 a[162:163], v17 offset:896
    ds_read_b128 v[100:103], v15 offset:8320
    s_waitcnt lgkmcnt(0)
    v_mfma_f32_16x16x32_bf16 v[104:107], a[144:147], v[56:59], v[104:107]
    ds_read_b64_tr_b16 a[164:165], v17 offset:136
    v_mfma_f32_16x16x32_bf16 v[128:131], a[144:147], v[80:83], v[128:131]
    ds_read_b64_tr_b16 a[166:167], v17 offset:904
    v_mfma_f32_16x16x32_bf16 v[108:111], a[148:151], v[56:59], v[108:111]
    ds_read_b64_tr_b16 a[168:169], v17 offset:6160
    v_mfma_f32_16x16x32_bf16 v[132:135], a[148:151], v[80:83], v[132:135]
    ds_read_b64_tr_b16 a[170:171], v17 offset:6928
    v_mfma_f32_16x16x32_bf16 v[112:115], a[152:155], v[56:59], v[112:115]
    ds_read_b64_tr_b16 a[172:173], v17 offset:6168
    v_mfma_f32_16x16x32_bf16 v[136:139], a[152:155], v[80:83], v[136:139]
    ds_read_b64_tr_b16 a[174:175], v17 offset:6936
    v_mfma_f32_16x16x32_bf16 v[116:119], a[156:159], v[56:59], v[116:119]
    ds_read_b64_tr_b16 a[176:177], v17 offset:6224
    v_mfma_f32_16x16x32_bf16 v[140:143], a[156:159], v[80:83], v[140:143]
    ds_read_b64_tr_b16 a[178:179], v17 offset:6992
    v_mfma_f32_16x16x32_bf16 v[120:123], a[160:163], v[56:59], v[120:123]
    ds_read_b64_tr_b16 a[180:181], v17 offset:6232
    v_mfma_f32_16x16x32_bf16 v[144:147], a[160:163], v[80:83], v[144:147]
    ds_read_b64_tr_b16 a[182:183], v17 offset:7000
    s_waitcnt lgkmcnt(8)
    v_mfma_f32_16x16x32_bf16 v[124:127], a[164:167], v[56:59], v[124:127]
    ds_read_b64_tr_b16 a[184:185], v17 offset:6288
    v_mfma_f32_16x16x32_bf16 v[148:151], a[164:167], v[80:83], v[148:151]
    ds_read_b64_tr_b16 a[186:187], v17 offset:7056
    s_waitcnt lgkmcnt(8)
    v_mfma_f32_16x16x32_bf16 v[104:107], a[168:171], v[60:63], v[104:107]
    ds_read_b64_tr_b16 a[188:189], v17 offset:6296
    v_mfma_f32_16x16x32_bf16 v[128:131], a[168:171], v[84:87], v[128:131]
    ds_read_b64_tr_b16 a[190:191], v17 offset:7064
    s_waitcnt lgkmcnt(8)
    v_mfma_f32_16x16x32_bf16 v[108:111], a[172:175], v[60:63], v[108:111]
    s_waitcnt vmcnt(12)
    s_barrier
    ds_read_b64_tr_b16 a[192:193], v17 offset:12320
    v_mfma_f32_16x16x32_bf16 v[132:135], a[172:175], v[84:87], v[132:135]
    ds_read_b64_tr_b16 a[194:195], v17 offset:13088
    s_waitcnt lgkmcnt(8)
    v_mfma_f32_16x16x32_bf16 v[112:115], a[176:179], v[60:63], v[112:115]
    ds_read_b64_tr_b16 a[196:197], v17 offset:12328
    v_mfma_f32_16x16x32_bf16 v[136:139], a[176:179], v[84:87], v[136:139]
    ds_read_b64_tr_b16 a[198:199], v17 offset:13096
    s_waitcnt lgkmcnt(8)
    v_mfma_f32_16x16x32_bf16 v[116:119], a[180:183], v[60:63], v[116:119]
    ds_read_b64_tr_b16 a[200:201], v17 offset:12384
    v_mfma_f32_16x16x32_bf16 v[140:143], a[180:183], v[84:87], v[140:143]
    ds_read_b64_tr_b16 a[202:203], v17 offset:13152
    s_waitcnt lgkmcnt(8)
    v_mfma_f32_16x16x32_bf16 v[120:123], a[184:187], v[60:63], v[120:123]
    ds_read_b64_tr_b16 a[204:205], v17 offset:12392
    v_mfma_f32_16x16x32_bf16 v[144:147], a[184:187], v[84:87], v[144:147]
    ds_read_b64_tr_b16 a[206:207], v17 offset:13160
    s_waitcnt lgkmcnt(8)
    v_mfma_f32_16x16x32_bf16 v[124:127], a[188:191], v[60:63], v[124:127]
    ds_read_b64_tr_b16 a[208:209], v17 offset:12448
    v_mfma_f32_16x16x32_bf16 v[148:151], a[188:191], v[84:87], v[148:151]
    ds_read_b64_tr_b16 a[210:211], v17 offset:13216
    s_waitcnt lgkmcnt(8)
    v_mfma_f32_16x16x32_bf16 v[104:107], a[192:195], v[64:67], v[104:107]
    ds_read_b64_tr_b16 a[212:213], v17 offset:12456
    v_mfma_f32_16x16x32_bf16 v[128:131], a[192:195], v[88:91], v[128:131]
    ds_read_b64_tr_b16 a[214:215], v17 offset:13224
    s_waitcnt lgkmcnt(8)
    v_mfma_f32_16x16x32_bf16 v[108:111], a[196:199], v[64:67], v[108:111]
    ds_read_b64_tr_b16 a[216:217], v17 offset:18480
    v_mfma_f32_16x16x32_bf16 v[132:135], a[196:199], v[88:91], v[132:135]
    ds_read_b64_tr_b16 a[218:219], v17 offset:19248
    s_waitcnt lgkmcnt(8)
    v_mfma_f32_16x16x32_bf16 v[112:115], a[200:203], v[64:67], v[112:115]
    ds_read_b64_tr_b16 a[220:221], v17 offset:18488
    v_mfma_f32_16x16x32_bf16 v[136:139], a[200:203], v[88:91], v[136:139]
    ds_read_b64_tr_b16 a[222:223], v17 offset:19256
    s_waitcnt lgkmcnt(8)
    v_mfma_f32_16x16x32_bf16 v[116:119], a[204:207], v[64:67], v[116:119]
    ds_read_b64_tr_b16 a[224:225], v17 offset:18544
    v_mfma_f32_16x16x32_bf16 v[140:143], a[204:207], v[88:91], v[140:143]
    ds_read_b64_tr_b16 a[226:227], v17 offset:19312
    s_waitcnt lgkmcnt(8)
    v_mfma_f32_16x16x32_bf16 v[120:123], a[208:211], v[64:67], v[120:123]
    ds_read_b64_tr_b16 a[228:229], v17 offset:18552
    v_mfma_f32_16x16x32_bf16 v[144:147], a[208:211], v[88:91], v[144:147]
    ds_read_b64_tr_b16 a[230:231], v17 offset:19320
    s_waitcnt lgkmcnt(8)
    v_mfma_f32_16x16x32_bf16 v[124:127], a[212:215], v[64:67], v[124:127]
    ds_read_b64_tr_b16 a[232:233], v17 offset:18608
    v_mfma_f32_16x16x32_bf16 v[148:151], a[212:215], v[88:91], v[148:151]
    ds_read_b64_tr_b16 a[234:235], v17 offset:19376
    s_waitcnt lgkmcnt(8)
    v_mfma_f32_16x16x32_bf16 v[104:107], a[216:219], v[68:71], v[104:107]
    ds_read_b64_tr_b16 a[236:237], v17 offset:18616
    v_mfma_f32_16x16x32_bf16 v[128:131], a[216:219], v[92:95], v[128:131]
    ds_read_b64_tr_b16 a[238:239], v17 offset:19384
    s_waitcnt lgkmcnt(8)
    v_mfma_f32_16x16x32_bf16 v[108:111], a[220:223], v[68:71], v[108:111]
    s_waitcnt vmcnt(9)
    s_barrier
    ds_read_b64_tr_b16 a[240:241], v17 offset:24640
    v_mfma_f32_16x16x32_bf16 v[132:135], a[220:223], v[92:95], v[132:135]
    ds_read_b64_tr_b16 a[242:243], v17 offset:25408
    s_waitcnt lgkmcnt(8)
    v_mfma_f32_16x16x32_bf16 v[112:115], a[224:227], v[68:71], v[112:115]
    ds_read_b64_tr_b16 a[244:245], v17 offset:24648
    v_mfma_f32_16x16x32_bf16 v[136:139], a[224:227], v[92:95], v[136:139]
    ds_read_b64_tr_b16 a[246:247], v17 offset:25416
    s_waitcnt lgkmcnt(8)
    v_mfma_f32_16x16x32_bf16 v[116:119], a[228:231], v[68:71], v[116:119]
    ds_read_b64_tr_b16 a[248:249], v17 offset:24704
    v_mfma_f32_16x16x32_bf16 v[140:143], a[228:231], v[92:95], v[140:143]
    ds_read_b64_tr_b16 a[250:251], v17 offset:25472
    s_waitcnt lgkmcnt(8)
    v_mfma_f32_16x16x32_bf16 v[120:123], a[232:235], v[68:71], v[120:123]
    ds_read_b64_tr_b16 a[252:253], v17 offset:24712
    v_mfma_f32_16x16x32_bf16 v[144:147], a[232:235], v[92:95], v[144:147]
    ds_read_b64_tr_b16 a[254:255], v17 offset:25480
    s_waitcnt lgkmcnt(8)
    v_mfma_f32_16x16x32_bf16 v[124:127], a[236:239], v[68:71], v[124:127]
    ds_read_b64_tr_b16 v[212:213], v17 offset:24768
    v_mfma_f32_16x16x32_bf16 v[148:151], a[236:239], v[92:95], v[148:151]
    ds_read_b64_tr_b16 v[214:215], v17 offset:25536
    s_waitcnt lgkmcnt(8)
    v_mfma_f32_16x16x32_bf16 v[104:107], a[240:243], v[72:75], v[104:107]
    ds_read_b64_tr_b16 v[216:217], v17 offset:24776
    s_waitcnt vmcnt(5)
    v_mfma_f32_16x16x32_bf16 v[128:131], a[240:243], v[96:99], v[128:131]
    ds_read_b64_tr_b16 v[218:219], v17 offset:25544
    s_waitcnt lgkmcnt(8)
    v_mfma_f32_16x16x32_bf16 v[108:111], a[244:247], v[72:75], v[108:111]
    ds_read_b64_tr_b16 v[220:221], v17 offset:30800
    v_mfma_f32_16x16x32_bf16 v[132:135], a[244:247], v[96:99], v[132:135]
    ds_read_b64_tr_b16 v[222:223], v17 offset:31568
    ds_read_b128 v[32:35], v14 offset:12288
    s_waitcnt lgkmcnt(9)
    v_mfma_f32_16x16x32_bf16 v[112:115], a[248:251], v[72:75], v[112:115]
    ds_read_b64_tr_b16 v[224:225], v17 offset:30808
    v_mfma_f32_16x16x32_bf16 v[136:139], a[248:251], v[96:99], v[136:139]
    ds_read_b64_tr_b16 v[226:227], v17 offset:31576
    ds_read_b128 v[36:39], v14 offset:12352
    s_waitcnt lgkmcnt(10)
    v_mfma_f32_16x16x32_bf16 v[116:119], a[252:255], v[72:75], v[116:119]
    ds_read_b64_tr_b16 v[228:229], v17 offset:30864
    v_mfma_f32_16x16x32_bf16 v[140:143], a[252:255], v[96:99], v[140:143]
    ds_read_b64_tr_b16 v[230:231], v17 offset:31632
    ds_read_b128 v[40:43], v14 offset:12416
    s_waitcnt lgkmcnt(11)
    v_mfma_f32_16x16x32_bf16 v[120:123], v[212:215], v[72:75], v[120:123]
    ds_read_b64_tr_b16 v[232:233], v17 offset:30872
    v_mfma_f32_16x16x32_bf16 v[144:147], v[212:215], v[96:99], v[144:147]
    ds_read_b64_tr_b16 v[234:235], v17 offset:31640
    ds_read_b128 v[44:47], v15 offset:12288
    s_waitcnt lgkmcnt(12)
    v_mfma_f32_16x16x32_bf16 v[124:127], v[216:219], v[72:75], v[124:127]
    ds_read_b64_tr_b16 v[236:237], v17 offset:30928
    v_mfma_f32_16x16x32_bf16 v[148:151], v[216:219], v[96:99], v[148:151]
    ds_read_b64_tr_b16 v[238:239], v17 offset:31696
    ds_read_b128 v[48:51], v15 offset:12352
    s_waitcnt lgkmcnt(13)
    v_mfma_f32_16x16x32_bf16 v[104:107], v[220:223], v[76:79], v[104:107]
    ds_read_b64_tr_b16 v[240:241], v17 offset:30936
    v_mfma_f32_16x16x32_bf16 v[128:131], v[220:223], v[100:103], v[128:131]
    ds_read_b64_tr_b16 v[242:243], v17 offset:31704
    ds_read_b128 v[52:55], v15 offset:12416
    s_waitcnt lgkmcnt(13)
    v_mfma_f32_16x16x32_bf16 v[108:111], v[224:227], v[76:79], v[108:111]
    v_mfma_f32_16x16x32_bf16 v[132:135], v[224:227], v[100:103], v[132:135]
    s_waitcnt lgkmcnt(10)
    v_mfma_f32_16x16x32_bf16 v[112:115], v[228:231], v[76:79], v[112:115]
    v_mfma_f32_16x16x32_bf16 v[136:139], v[228:231], v[100:103], v[136:139]
    s_waitcnt lgkmcnt(7)
    v_mfma_f32_16x16x32_bf16 v[116:119], v[232:235], v[76:79], v[116:119]
    v_mfma_f32_16x16x32_bf16 v[140:143], v[232:235], v[100:103], v[140:143]
    s_waitcnt lgkmcnt(4)
    v_mfma_f32_16x16x32_bf16 v[120:123], v[236:239], v[76:79], v[120:123]
    v_mfma_f32_16x16x32_bf16 v[144:147], v[236:239], v[100:103], v[144:147]
    s_waitcnt lgkmcnt(1)
    v_mfma_f32_16x16x32_bf16 v[124:127], v[240:243], v[76:79], v[124:127]
    v_mfma_f32_16x16x32_bf16 v[148:151], v[240:243], v[100:103], v[148:151]
    s_lshr_b32 s41, s2, 5
    s_xor_b32 s41, s41, s2
    s_bitcmp1_b32 s41, 0
    s_cbranch_scc0 L_row2_alt
    v_mfma_f32_16x16x32_bf16 v[152:155], a[0:3], v[80:83], v[160:163]
    v_cvt_pk_bf16_f32 v184, v104, v105
    v_mfma_f32_16x16x32_bf16 v[152:155], a[24:27], v[84:87], v[152:155]
    v_cvt_pk_bf16_f32 v185, v106, v107
    s_add_u32 s58, s57, 172032
    v_mfma_f32_16x16x32_bf16 v[152:155], a[48:51], v[88:91], v[152:155]
    v_cvt_pk_bf16_f32 v186, v108, v109
    v_mfma_f32_16x16x32_bf16 v[152:155], a[72:75], v[92:95], v[152:155]
    v_cvt_pk_bf16_f32 v187, v110, v111
    v_mfma_f32_16x16x32_bf16 v[152:155], a[96:99], v[96:99], v[152:155]
    ds_write_b128 v30, v[184:187] offset:0
    s_waitcnt lgkmcnt(1)
    v_mfma_f32_16x16x32_bf16 v[152:155], a[120:123], v[100:103], v[152:155]
    v_mfma_f32_16x16x32_bf16 v[152:155], a[144:147], v[32:35], v[152:155]
    v_cvt_pk_bf16_f32 v188, v112, v113
    v_mfma_f32_16x16x32_bf16 v[152:155], a[168:171], v[36:39], v[152:155]
    v_cvt_pk_bf16_f32 v189, v114, v115
    v_mfma_f32_16x16x32_bf16 v[152:155], a[192:195], v[40:43], v[152:155]
    v_cvt_pk_bf16_f32 v190, v116, v117
    v_mfma_f32_16x16x32_bf16 v[152:155], a[216:219], v[44:47], v[152:155]
    v_cvt_pk_bf16_f32 v191, v118, v119
    v_mfma_f32_16x16x32_bf16 v[152:155], a[240:243], v[48:51], v[152:155]
    ds_write_b128 v30, v[188:191] offset:1024
    v_mfma_f32_16x16x32_bf16 v[152:155], v[220:223], v[52:55], v[152:155]
    v_mfma_f32_16x16x32_bf16 v[156:159], a[4:7], v[80:83], v[164:167]
    v_cvt_pk_bf16_f32 v192, v120, v121
    v_mfma_f32_16x16x32_bf16 v[156:159], a[28:31], v[84:87], v[156:159]
    v_cvt_pk_bf16_f32 v193, v122, v123
    v_mfma_f32_16x16x32_bf16 v[156:159], a[52:55], v[88:91], v[156:159]
    v_cvt_pk_bf16_f32 v194, v124, v125
    v_mfma_f32_16x16x32_bf16 v[156:159], a[76:79], v[92:95], v[156:159]
    v_cvt_pk_bf16_f32 v195, v126, v127
    v_mfma_f32_16x16x32_bf16 v[156:159], a[100:103], v[96:99], v[156:159]
    ds_write_b128 v30, v[192:195] offset:2048
    v_mfma_f32_16x16x32_bf16 v[156:159], a[124:127], v[100:103], v[156:159]
    v_mfma_f32_16x16x32_bf16 v[156:159], a[148:151], v[32:35], v[156:159]
    v_cvt_pk_bf16_f32 v196, v128, v129
    v_mfma_f32_16x16x32_bf16 v[156:159], a[172:175], v[36:39], v[156:159]
    v_cvt_pk_bf16_f32 v197, v130, v131
    v_mfma_f32_16x16x32_bf16 v[156:159], a[196:199], v[40:43], v[156:159]
    v_cvt_pk_bf16_f32 v198, v132, v133
    v_mfma_f32_16x16x32_bf16 v[156:159], a[220:223], v[44:47], v[156:159]
    v_cvt_pk_bf16_f32 v199, v134, v135
    v_mfma_f32_16x16x32_bf16 v[156:159], a[244:247], v[48:51], v[156:159]
    ds_write_b128 v30, v[196:199] offset:3072
    v_mfma_f32_16x16x32_bf16 v[156:159], v[224:227], v[52:55], v[156:159]
    v_mfma_f32_16x16x32_bf16 v[104:107], a[8:11], v[80:83], v[168:171]
    v_cvt_pk_bf16_f32 v184, v136, v137
    v_cvt_pk_bf16_f32 v188, v152, v153
    v_mfma_f32_16x16x32_bf16 v[104:107], a[32:35], v[84:87], v[104:107]
    v_cvt_pk_bf16_f32 v185, v138, v139
    v_cvt_pk_bf16_f32 v189, v154, v155
    v_mfma_f32_16x16x32_bf16 v[104:107], a[56:59], v[88:91], v[104:107]
    v_cvt_pk_bf16_f32 v186, v140, v141
    v_mfma_f32_16x16x32_bf16 v[104:107], a[80:83], v[92:95], v[104:107]
    v_cvt_pk_bf16_f32 v187, v142, v143
    v_mfma_f32_16x16x32_bf16 v[104:107], a[104:107], v[96:99], v[104:107]
    ds_write_b128 v30, v[184:187] offset:4096
    v_mfma_f32_16x16x32_bf16 v[104:107], a[128:131], v[100:103], v[104:107]
    v_mfma_f32_16x16x32_bf16 v[104:107], a[152:155], v[32:35], v[104:107]
    v_cvt_pk_bf16_f32 v192, v144, v145
    v_mfma_f32_16x16x32_bf16 v[104:107], a[176:179], v[36:39], v[104:107]
    v_cvt_pk_bf16_f32 v193, v146, v147
    v_mfma_f32_16x16x32_bf16 v[104:107], a[200:203], v[40:43], v[104:107]
    v_cvt_pk_bf16_f32 v194, v148, v149
    v_cvt_pk_bf16_f32 v190, v156, v157
    v_mfma_f32_16x16x32_bf16 v[104:107], a[224:227], v[44:47], v[104:107]
    v_cvt_pk_bf16_f32 v195, v150, v151
    v_cvt_pk_bf16_f32 v191, v158, v159
    v_mfma_f32_16x16x32_bf16 v[104:107], a[248:251], v[48:51], v[104:107]
    ds_write_b128 v30, v[192:195] offset:5120
    ds_write_b128 v30, v[188:191] offset:6144
    v_mfma_f32_16x16x32_bf16 v[104:107], v[228:231], v[52:55], v[104:107]
    v_mfma_f32_16x16x32_bf16 v[108:111], a[12:15], v[80:83], v[172:175]
    v_mfma_f32_16x16x32_bf16 v[108:111], a[36:39], v[84:87], v[108:111]
    v_mfma_f32_16x16x32_bf16 v[108:111], a[60:63], v[88:91], v[108:111]
    v_mfma_f32_16x16x32_bf16 v[108:111], a[84:87], v[92:95], v[108:111]
    v_mfma_f32_16x16x32_bf16 v[108:111], a[108:111], v[96:99], v[108:111]
    s_waitcnt vmcnt(1)
    v_mfma_f32_16x16x32_bf16 v[108:111], a[132:135], v[100:103], v[108:111]
    ds_read_b128 v[56:59], v14 offset:16384
    v_mfma_f32_16x16x32_bf16 v[108:111], a[156:159], v[32:35], v[108:111]
    ds_read_b128 v[60:63], v14 offset:16448
    v_mfma_f32_16x16x32_bf16 v[108:111], a[180:183], v[36:39], v[108:111]
    ds_read_b128 v[64:67], v14 offset:16512
    v_mfma_f32_16x16x32_bf16 v[108:111], a[204:207], v[40:43], v[108:111]
    v_mfma_f32_16x16x32_bf16 v[108:111], a[228:231], v[44:47], v[108:111]
    v_mfma_f32_16x16x32_bf16 v[108:111], a[252:255], v[48:51], v[108:111]
    v_mfma_f32_16x16x32_bf16 v[108:111], v[232:235], v[52:55], v[108:111]
    v_mfma_f32_16x16x32_bf16 v[112:115], a[16:19], v[80:83], v[176:179]
    v_cvt_pk_bf16_f32 v196, v104, v105
    v_mfma_f32_16x16x32_bf16 v[112:115], a[40:43], v[84:87], v[112:115]
    s_add_u32 m0, s47, 0
    v_cvt_pk_bf16_f32 v197, v106, v107
    v_mfma_f32_16x16x32_bf16 v[112:115], a[64:67], v[88:91], v[112:115]
    buffer_load_dwordx4 v7, s[12:15], s45 offen lds
    ds_read_b128 v[68:71], v15 offset:16384
    v_mfma_f32_16x16x32_bf16 v[112:115], a[88:91], v[92:95], v[112:115]
    ds_read_b128 v[72:75], v15 offset:16448
    v_mfma_f32_16x16x32_bf16 v[112:115], a[112:115], v[96:99], v[112:115]
    ds_read_b128 v[76:79], v15 offset:16512
    v_mfma_f32_16x16x32_bf16 v[112:115], a[136:139], v[100:103], v[112:115]
    v_mfma_f32_16x16x32_bf16 v[112:115], a[160:163], v[32:35], v[112:115]
    v_mfma_f32_16x16x32_bf16 v[112:115], a[184:187], v[36:39], v[112:115]
    buffer_load_dwordx4 v8, s[12:15], s45 offen offset:1024 lds
    v_mfma_f32_16x16x32_bf16 v[112:115], a[208:211], v[40:43], v[112:115]
    v_cvt_pk_bf16_f32 v198, v108, v109
    v_mfma_f32_16x16x32_bf16 v[112:115], a[232:235], v[44:47], v[112:115]
    v_cvt_pk_bf16_f32 v199, v110, v111
    v_mfma_f32_16x16x32_bf16 v[112:115], v[212:215], v[48:51], v[112:115]
    ds_write_b128 v30, v[196:199] offset:7168
    v_mfma_f32_16x16x32_bf16 v[112:115], v[236:239], v[52:55], v[112:115]
    v_mfma_f32_16x16x32_bf16 v[116:119], a[20:23], v[80:83], v[180:183]
    buffer_load_dwordx4 v9, s[12:15], s45 offen offset:2048 lds
    v_mfma_f32_16x16x32_bf16 v[116:119], a[44:47], v[84:87], v[116:119]
    v_mfma_f32_16x16x32_bf16 v[116:119], a[68:71], v[88:91], v[116:119]
    v_mfma_f32_16x16x32_bf16 v[116:119], a[92:95], v[92:95], v[116:119]
    v_mfma_f32_16x16x32_bf16 v[116:119], a[116:119], v[96:99], v[116:119]
    v_mfma_f32_16x16x32_bf16 v[116:119], a[140:143], v[100:103], v[116:119]
    s_mov_b64 exec, 0xfff
    buffer_load_dwordx4 v10, s[12:15], s45 offen offset:3072 lds
    s_mov_b64 exec, -1
    s_add_u32 s45, s45, 43008
    s_add_u32 s46, s46, 1
    v_mfma_f32_16x16x32_bf16 v[116:119], a[164:167], v[32:35], v[116:119]
    s_waitcnt lgkmcnt(1)
    v_mfma_f32_16x16x32_bf16 v[116:119], a[188:191], v[36:39], v[116:119]
    v_mfma_f32_16x16x32_bf16 v[116:119], a[212:215], v[40:43], v[116:119]
    v_mfma_f32_16x16x32_bf16 v[116:119], a[236:239], v[44:47], v[116:119]
    v_mfma_f32_16x16x32_bf16 v[116:119], v[216:219], v[48:51], v[116:119]
    v_mfma_f32_16x16x32_bf16 v[116:119], v[240:243], v[52:55], v[116:119]
L_row3:
    v_mfma_f32_16x16x32_bf16 v[120:123], a[0:3], v[32:35], v[160:163]
    v_cvt_pk_bf16_f32 v184, v112, v113
    v_mfma_f32_16x16x32_bf16 v[120:123], a[24:27], v[36:39], v[120:123]
    v_cvt_pk_bf16_f32 v185, v114, v115
    s_add_u32 s59, s58, 172032
    s_add_u32 m0, s47, 4096
    v_mfma_f32_16x16x32_bf16 v[120:123], a[48:51], v[40:43], v[120:123]
    buffer_load_dwordx4 v7, s[12:15], s45 offen lds
    v_mfma_f32_16x16x32_bf16 v[120:123], a[72:75], v[44:47], v[120:123]
    v_mfma_f32_16x16x32_bf16 v[120:123], a[96:99], v[48:51], v[120:123]
    buffer_load_dwordx4 v8, s[12:15], s45 offen offset:1024 lds
    v_mfma_f32_16x16x32_bf16 v[120:123], a[120:123], v[52:55], v[120:123]
    v_mfma_f32_16x16x32_bf16 v[120:123], a[144:147], v[56:59], v[120:123]
    v_mfma_f32_16x16x32_bf16 v[120:123], a[168:171], v[60:63], v[120:123]
    v_mfma_f32_16x16x32_bf16 v[120:123], a[192:195], v[64:67], v[120:123]
    v_cvt_pk_bf16_f32 v186, v116, v117
    v_mfma_f32_16x16x32_bf16 v[120:123], a[216:219], v[68:71], v[120:123]
    v_cvt_pk_bf16_f32 v187, v118, v119
    v_mfma_f32_16x16x32_bf16 v[120:123], a[240:243], v[72:75], v[120:123]
    ds_write_b128 v30, v[184:187] offset:8192
    v_mfma_f32_16x16x32_bf16 v[120:123], v[220:223], v[76:79], v[120:123]
    v_mfma_f32_16x16x32_bf16 v[124:127], a[4:7], v[32:35], v[164:167]
    v_mfma_f32_16x16x32_bf16 v[124:127], a[28:31], v[36:39], v[124:127]
    v_mfma_f32_16x16x32_bf16 v[124:127], a[52:55], v[40:43], v[124:127]
    v_mfma_f32_16x16x32_bf16 v[124:127], a[76:79], v[44:47], v[124:127]
    v_mfma_f32_16x16x32_bf16 v[124:127], a[100:103], v[48:51], v[124:127]
    v_mfma_f32_16x16x32_bf16 v[124:127], a[124:127], v[52:55], v[124:127]
    v_mfma_f32_16x16x32_bf16 v[124:127], a[148:151], v[56:59], v[124:127]
    v_mfma_f32_16x16x32_bf16 v[124:127], a[172:175], v[60:63], v[124:127]
    v_mfma_f32_16x16x32_bf16 v[124:127], a[196:199], v[64:67], v[124:127]
    v_mfma_f32_16x16x32_bf16 v[124:127], a[220:223], v[68:71], v[124:127]
    v_mfma_f32_16x16x32_bf16 v[124:127], a[244:247], v[72:75], v[124:127]
    v_mfma_f32_16x16x32_bf16 v[124:127], v[224:227], v[76:79], v[124:127]
    v_mfma_f32_16x16x32_bf16 v[128:131], a[8:11], v[32:35], v[168:171]
    v_cvt_pk_bf16_f32 v192, v120, v121
    v_mfma_f32_16x16x32_bf16 v[128:131], a[32:35], v[36:39], v[128:131]
    v_cvt_pk_bf16_f32 v193, v122, v123
    v_mfma_f32_16x16x32_bf16 v[128:131], a[56:59], v[40:43], v[128:131]
    buffer_load_dwordx4 v9, s[12:15], s45 offen offset:2048 lds
    v_mfma_f32_16x16x32_bf16 v[128:131], a[80:83], v[44:47], v[128:131]
    v_mfma_f32_16x16x32_bf16 v[128:131], a[104:107], v[48:51], v[128:131]
    s_mov_b64 exec, 0xfff
    buffer_load_dwordx4 v10, s[12:15], s45 offen offset:3072 lds
    s_mov_b64 exec, -1
    s_add_u32 s45, s45, 43008
    s_add_u32 s46, s46, 1
    v_mfma_f32_16x16x32_bf16 v[128:131], a[128:131], v[52:55], v[128:131]
    v_mfma_f32_16x16x32_bf16 v[128:131], a[152:155], v[56:59], v[128:131]
    v_mfma_f32_16x16x32_bf16 v[128:131], a[176:179], v[60:63], v[128:131]
    v_mfma_f32_16x16x32_bf16 v[128:131], a[200:203], v[64:67], v[128:131]
    v_cvt_pk_bf16_f32 v194, v124, v125
    v_mfma_f32_16x16x32_bf16 v[128:131], a[224:227], v[68:71], v[128:131]
    v_cvt_pk_bf16_f32 v195, v126, v127
    v_mfma_f32_16x16x32_bf16 v[128:131], a[248:251], v[72:75], v[128:131]
    buffer_store_dwordx4 v[192:195], v18, s[28:31], s59 offen sc1
    v_mfma_f32_16x16x32_bf16 v[128:131], v[228:231], v[76:79], v[128:131]
    v_mfma_f32_16x16x32_bf16 v[132:135], a[12:15], v[32:35], v[172:175]
    v_mfma_f32_16x16x32_bf16 v[132:135], a[36:39], v[36:39], v[132:135]
    v_mfma_f32_16x16x32_bf16 v[132:135], a[60:63], v[40:43], v[132:135]
    v_mfma_f32_16x16x32_bf16 v[132:135], a[84:87], v[44:47], v[132:135]
    v_mfma_f32_16x16x32_bf16 v[132:135], a[108:111], v[48:51], v[132:135]
    ds_read_b128 v[200:203], v31 offset:0
    s_waitcnt vmcnt(5)
    v_mfma_f32_16x16x32_bf16 v[132:135], a[132:135], v[52:55], v[132:135]
    ds_read_b128 v[80:83], v14 offset:0
    v_mfma_f32_16x16x32_bf16 v[132:135], a[156:159], v[56:59], v[132:135]
    ds_read_b128 v[84:87], v14 offset:64
    v_mfma_f32_16x16x32_bf16 v[132:135], a[180:183], v[60:63], v[132:135]
    ds_read_b128 v[88:91], v14 offset:128
    v_mfma_f32_16x16x32_bf16 v[132:135], a[204:207], v[64:67], v[132:135]
    v_mfma_f32_16x16x32_bf16 v[132:135], a[228:231], v[68:71], v[132:135]
    v_mfma_f32_16x16x32_bf16 v[132:135], a[252:255], v[72:75], v[132:135]
    s_waitcnt lgkmcnt(3)
    v_mfma_f32_16x16x32_bf16 v[132:135], v[232:235], v[76:79], v[132:135]
    buffer_store_dwordx4 v[200:203], v20, s[28:31], s92 offen sc1
    v_mfma_f32_16x16x32_bf16 v[136:139], a[16:19], v[32:35], v[176:179]
    v_cvt_pk_bf16_f32 v188, v128, v129
    v_mfma_f32_16x16x32_bf16 v[136:139], a[40:43], v[36:39], v[136:139]
    v_cvt_pk_bf16_f32 v189, v130, v131
    v_mfma_f32_16x16x32_bf16 v[136:139], a[64:67], v[40:43], v[136:139]
    ds_read_b128 v[92:95], v15 offset:0
    v_mfma_f32_16x16x32_bf16 v[136:139], a[88:91], v[44:47], v[136:139]
    ds_read_b128 v[96:99], v15 offset:64
    v_mfma_f32_16x16x32_bf16 v[136:139], a[112:115], v[48:51], v[136:139]
    ds_read_b128 v[100:103], v15 offset:128
    v_mfma_f32_16x16x32_bf16 v[136:139], a[136:139], v[52:55], v[136:139]
    v_mfma_f32_16x16x32_bf16 v[136:139], a[160:163], v[56:59], v[136:139]
    v_mfma_f32_16x16x32_bf16 v[136:139], a[184:187], v[60:63], v[136:139]
    v_mfma_f32_16x16x32_bf16 v[136:139], a[208:211], v[64:67], v[136:139]
    v_cvt_pk_bf16_f32 v190, v132, v133
    v_mfma_f32_16x16x32_bf16 v[136:139], a[232:235], v[68:71], v[136:139]
    v_cvt_pk_bf16_f32 v191, v134, v135
    v_mfma_f32_16x16x32_bf16 v[136:139], v[212:215], v[72:75], v[136:139]
    buffer_store_dwordx4 v[188:191], v18, s[28:31], s59 offen offset:64 sc1
    v_mfma_f32_16x16x32_bf16 v[136:139], v[236:239], v[76:79], v[136:139]
    v_mfma_f32_16x16x32_bf16 v[152:155], a[20:23], v[32:35], v[180:183]
    v_mfma_f32_16x16x32_bf16 v[152:155], a[44:47], v[36:39], v[152:155]
    v_mfma_f32_16x16x32_bf16 v[152:155], a[68:71], v[40:43], v[152:155]
    v_mfma_f32_16x16x32_bf16 v[152:155], a[92:95], v[44:47], v[152:155]
    v_mfma_f32_16x16x32_bf16 v[152:155], a[116:119], v[48:51], v[152:155]
    v_mfma_f32_16x16x32_bf16 v[152:155], a[140:143], v[52:55], v[152:155]
    v_mfma_f32_16x16x32_bf16 v[152:155], a[164:167], v[56:59], v[152:155]
    s_waitcnt lgkmcnt(0)
    v_mfma_f32_16x16x32_bf16 v[152:155], a[188:191], v[60:63], v[152:155]
    v_mfma_f32_16x16x32_bf16 v[152:155], a[212:215], v[64:67], v[152:155]
    v_mfma_f32_16x16x32_bf16 v[152:155], a[236:239], v[68:71], v[152:155]
    v_mfma_f32_16x16x32_bf16 v[152:155], v[216:219], v[72:75], v[152:155]
    v_mfma_f32_16x16x32_bf16 v[152:155], v[240:243], v[76:79], v[152:155]
    v_mfma_f32_16x16x32_bf16 v[140:143], a[0:3], v[56:59], v[160:163]
    v_cvt_pk_bf16_f32 v196, v136, v137
    v_mfma_f32_16x16x32_bf16 v[140:143], a[24:27], v[60:63], v[140:143]
    v_cvt_pk_bf16_f32 v197, v138, v139
    s_add_u32 s56, s59, 172032
    s_add_u32 m0, s47, 8192
    v_mfma_f32_16x16x32_bf16 v[140:143], a[48:51], v[64:67], v[140:143]
    buffer_load_dwordx4 v7, s[12:15], s45 offen lds
    v_mfma_f32_16x16x32_bf16 v[140:143], a[72:75], v[68:71], v[140:143]
    v_mfma_f32_16x16x32_bf16 v[140:143], a[96:99], v[72:75], v[140:143]
    buffer_load_dwordx4 v8, s[12:15], s45 offen offset:1024 lds
    v_mfma_f32_16x16x32_bf16 v[140:143], a[120:123], v[76:79], v[140:143]
    v_mfma_f32_16x16x32_bf16 v[140:143], a[144:147], v[80:83], v[140:143]
    v_mfma_f32_16x16x32_bf16 v[140:143], a[168:171], v[84:87], v[140:143]
    v_mfma_f32_16x16x32_bf16 v[140:143], a[192:195], v[88:91], v[140:143]
    v_cvt_pk_bf16_f32 v198, v152, v153
    v_mfma_f32_16x16x32_bf16 v[140:143], a[216:219], v[92:95], v[140:143]
    v_cvt_pk_bf16_f32 v199, v154, v155
    v_mfma_f32_16x16x32_bf16 v[140:143], a[240:243], v[96:99], v[140:143]
    buffer_store_dwordx4 v[196:199], v18, s[28:31], s59 offen offset:128 sc1
    v_mfma_f32_16x16x32_bf16 v[140:143], v[220:223], v[100:103], v[140:143]
    v_mfma_f32_16x16x32_bf16 v[144:147], a[4:7], v[56:59], v[164:167]
    v_mfma_f32_16x16x32_bf16 v[144:147], a[28:31], v[60:63], v[144:147]
    v_mfma_f32_16x16x32_bf16 v[144:147], a[52:55], v[64:67], v[144:147]
    v_mfma_f32_16x16x32_bf16 v[144:147], a[76:79], v[68:71], v[144:147]
    v_mfma_f32_16x16x32_bf16 v[144:147], a[100:103], v[72:75], v[144:147]
    v_mfma_f32_16x16x32_bf16 v[144:147], a[124:127], v[76:79], v[144:147]
    v_mfma_f32_16x16x32_bf16 v[144:147], a[148:151], v[80:83], v[144:147]
    v_mfma_f32_16x16x32_bf16 v[144:147], a[172:175], v[84:87], v[144:147]
    v_mfma_f32_16x16x32_bf16 v[144:147], a[196:199], v[88:91], v[144:147]
    v_mfma_f32_16x16x32_bf16 v[144:147], a[220:223], v[92:95], v[144:147]
    v_mfma_f32_16x16x32_bf16 v[144:147], a[244:247], v[96:99], v[144:147]
    v_mfma_f32_16x16x32_bf16 v[144:147], v[224:227], v[100:103], v[144:147]
    v_mfma_f32_16x16x32_bf16 v[148:151], a[8:11], v[56:59], v[168:171]
    v_cvt_pk_bf16_f32 v184, v140, v141
    v_mfma_f32_16x16x32_bf16 v[148:151], a[32:35], v[60:63], v[148:151]
    v_cvt_pk_bf16_f32 v185, v142, v143
    v_mfma_f32_16x16x32_bf16 v[148:151], a[56:59], v[64:67], v[148:151]
    buffer_load_dwordx4 v9, s[12:15], s45 offen offset:2048 lds
    v_mfma_f32_16x16x32_bf16 v[148:151], a[80:83], v[68:71], v[148:151]
    v_mfma_f32_16x16x32_bf16 v[148:151], a[104:107], v[72:75], v[148:151]
    s_mov_b64 exec, 0xfff
    buffer_load_dwordx4 v10, s[12:15], s45 offen offset:3072 lds
    s_mov_b64 exec, -1
    s_add_u32 s45, s45, 43008
    s_add_u32 s46, s46, 1
    v_mfma_f32_16x16x32_bf16 v[148:151], a[128:131], v[76:79], v[148:151]
    v_mfma_f32_16x16x32_bf16 v[148:151], a[152:155], v[80:83], v[148:151]
    v_mfma_f32_16x16x32_bf16 v[148:151], a[176:179], v[84:87], v[148:151]
    v_mfma_f32_16x16x32_bf16 v[148:151], a[200:203], v[88:91], v[148:151]
    v_cvt_pk_bf16_f32 v186, v144, v145
    v_mfma_f32_16x16x32_bf16 v[148:151], a[224:227], v[92:95], v[148:151]
    v_cvt_pk_bf16_f32 v187, v146, v147
    v_mfma_f32_16x16x32_bf16 v[148:151], a[248:251], v[96:99], v[148:151]
    buffer_store_dwordx4 v[184:187], v18, s[28:31], s56 offen sc1
    v_mfma_f32_16x16x32_bf16 v[148:151], v[228:231], v[100:103], v[148:151]
    v_mfma_f32_16x16x32_bf16 v[156:159], a[12:15], v[56:59], v[172:175]
    v_mfma_f32_16x16x32_bf16 v[156:159], a[36:39], v[60:63], v[156:159]
    v_mfma_f32_16x16x32_bf16 v[156:159], a[60:63], v[64:67], v[156:159]
    v_mfma_f32_16x16x32_bf16 v[156:159], a[84:87], v[68:71], v[156:159]
    v_mfma_f32_16x16x32_bf16 v[156:159], a[108:111], v[72:75], v[156:159]
    ds_read_b128 v[204:207], v31 offset:1024
    s_waitcnt vmcnt(9)
    v_mfma_f32_16x16x32_bf16 v[156:159], a[132:135], v[76:79], v[156:159]
    ds_read_b128 v[32:35], v14 offset:4096
    v_mfma_f32_16x16x32_bf16 v[156:159], a[156:159], v[80:83], v[156:159]
    ds_read_b128 v[36:39], v14 offset:4160
    v_mfma_f32_16x16x32_bf16 v[156:159], a[180:183], v[84:87], v[156:159]
    ds_read_b128 v[40:43], v14 offset:4224
    v_mfma_f32_16x16x32_bf16 v[156:159], a[204:207], v[88:91], v[156:159]
    v_mfma_f32_16x16x32_bf16 v[156:159], a[228:231], v[92:95], v[156:159]
    v_mfma_f32_16x16x32_bf16 v[156:159], a[252:255], v[96:99], v[156:159]
    s_waitcnt lgkmcnt(3)
    v_mfma_f32_16x16x32_bf16 v[156:159], v[232:235], v[100:103], v[156:159]
    buffer_store_dwordx4 v[204:207], v20, s[28:31], s92 offen offset:64 sc1
    v_mfma_f32_16x16x32_bf16 v[104:107], a[16:19], v[56:59], v[176:179]
    v_cvt_pk_bf16_f32 v192, v148, v149
    v_mfma_f32_16x16x32_bf16 v[104:107], a[40:43], v[60:63], v[104:107]
    v_cvt_pk_bf16_f32 v193, v150, v151
    v_mfma_f32_16x16x32_bf16 v[104:107], a[64:67], v[64:67], v[104:107]
    ds_read_b128 v[44:47], v15 offset:4096
    v_mfma_f32_16x16x32_bf16 v[104:107], a[88:91], v[68:71], v[104:107]
    ds_read_b128 v[48:51], v15 offset:4160
    v_mfma_f32_16x16x32_bf16 v[104:107], a[112:115], v[72:75], v[104:107]
    ds_read_b128 v[52:55], v15 offset:4224
    v_mfma_f32_16x16x32_bf16 v[104:107], a[136:139], v[76:79], v[104:107]
    v_mfma_f32_16x16x32_bf16 v[104:107], a[160:163], v[80:83], v[104:107]
    v_mfma_f32_16x16x32_bf16 v[104:107], a[184:187], v[84:87], v[104:107]
    v_mfma_f32_16x16x32_bf16 v[104:107], a[208:211], v[88:91], v[104:107]
    v_cvt_pk_bf16_f32 v194, v156, v157
    v_mfma_f32_16x16x32_bf16 v[104:107], a[232:235], v[92:95], v[104:107]
    v_cvt_pk_bf16_f32 v195, v158, v159
    v_mfma_f32_16x16x32_bf16 v[104:107], v[212:215], v[96:99], v[104:107]
    buffer_store_dwordx4 v[192:195], v18, s[28:31], s56 offen offset:64 sc1
    v_mfma_f32_16x16x32_bf16 v[104:107], v[236:239], v[100:103], v[104:107]
    v_mfma_f32_16x16x32_bf16 v[108:111], a[20:23], v[56:59], v[180:183]
    v_mfma_f32_16x16x32_bf16 v[108:111], a[44:47], v[60:63], v[108:111]
    v_mfma_f32_16x16x32_bf16 v[108:111], a[68:71], v[64:67], v[108:111]
    v_mfma_f32_16x16x32_bf16 v[108:111], a[92:95], v[68:71], v[108:111]
    v_mfma_f32_16x16x32_bf16 v[108:111], a[116:119], v[72:75], v[108:111]
    v_mfma_f32_16x16x32_bf16 v[108:111], a[140:143], v[76:79], v[108:111]
    v_mfma_f32_16x16x32_bf16 v[108:111], a[164:167], v[80:83], v[108:111]
    s_waitcnt lgkmcnt(0)
    v_mfma_f32_16x16x32_bf16 v[108:111], a[188:191], v[84:87], v[108:111]
    v_mfma_f32_16x16x32_bf16 v[108:111], a[212:215], v[88:91], v[108:111]
    v_mfma_f32_16x16x32_bf16 v[108:111], a[236:239], v[92:95], v[108:111]
    v_mfma_f32_16x16x32_bf16 v[108:111], v[216:219], v[96:99], v[108:111]
    v_mfma_f32_16x16x32_bf16 v[108:111], v[240:243], v[100:103], v[108:111]
    v_mfma_f32_16x16x32_bf16 v[112:115], a[0:3], v[80:83], v[160:163]
    v_cvt_pk_bf16_f32 v188, v104, v105
    v_mfma_f32_16x16x32_bf16 v[112:115], a[24:27], v[84:87], v[112:115]
    v_cvt_pk_bf16_f32 v189, v106, v107
    s_add_u32 s57, s56, 172032
    s_add_u32 m0, s47, 12288
    v_mfma_f32_16x16x32_bf16 v[112:115], a[48:51], v[88:91], v[112:115]
    buffer_load_dwordx4 v7, s[12:15], s45 offen lds
    v_mfma_f32_16x16x32_bf16 v[112:115], a[72:75], v[92:95], v[112:115]
    v_mfma_f32_16x16x32_bf16 v[112:115], a[96:99], v[96:99], v[112:115]
    buffer_load_dwordx4 v8, s[12:15], s45 offen offset:1024 lds
    v_mfma_f32_16x16x32_bf16 v[112:115], a[120:123], v[100:103], v[112:115]
    v_mfma_f32_16x16x32_bf16 v[112:115], a[144:147], v[32:35], v[112:115]
    v_mfma_f32_16x16x32_bf16 v[112:115], a[168:171], v[36:39], v[112:115]
    v_mfma_f32_16x16x32_bf16 v[112:115], a[192:195], v[40:43], v[112:115]
    v_cvt_pk_bf16_f32 v190, v108, v109
    v_mfma_f32_16x16x32_bf16 v[112:115], a[216:219], v[44:47], v[112:115]
    v_cvt_pk_bf16_f32 v191, v110, v111
    v_mfma_f32_16x16x32_bf16 v[112:115], a[240:243], v[48:51], v[112:115]
    buffer_store_dwordx4 v[188:191], v18, s[28:31], s56 offen offset:128 sc1
    v_mfma_f32_16x16x32_bf16 v[112:115], v[220:223], v[52:55], v[112:115]
    v_mfma_f32_16x16x32_bf16 v[116:119], a[4:7], v[80:83], v[164:167]
    v_mfma_f32_16x16x32_bf16 v[116:119], a[28:31], v[84:87], v[116:119]
    v_mfma_f32_16x16x32_bf16 v[116:119], a[52:55], v[88:91], v[116:119]
    v_mfma_f32_16x16x32_bf16 v[116:119], a[76:79], v[92:95], v[116:119]
    v_mfma_f32_16x16x32_bf16 v[116:119], a[100:103], v[96:99], v[116:119]
    v_mfma_f32_16x16x32_bf16 v[116:119], a[124:127], v[100:103], v[116:119]
    v_mfma_f32_16x16x32_bf16 v[116:119], a[148:151], v[32:35], v[116:119]
    v_mfma_f32_16x16x32_bf16 v[116:119], a[172:175], v[36:39], v[116:119]
    v_mfma_f32_16x16x32_bf16 v[116:119], a[196:199], v[40:43], v[116:119]
    v_mfma_f32_16x16x32_bf16 v[116:119], a[220:223], v[44:47], v[116:119]
    v_mfma_f32_16x16x32_bf16 v[116:119], a[244:247], v[48:51], v[116:119]
    v_mfma_f32_16x16x32_bf16 v[116:119], v[224:227], v[52:55], v[116:119]
    v_mfma_f32_16x16x32_bf16 v[120:123], a[8:11], v[80:83], v[168:171]
    v_cvt_pk_bf16_f32 v196, v112, v113
    v_mfma_f32_16x16x32_bf16 v[120:123], a[32:35], v[84:87], v[120:123]
    v_cvt_pk_bf16_f32 v197, v114, v115
    v_mfma_f32_16x16x32_bf16 v[120:123], a[56:59], v[88:91], v[120:123]
    buffer_load_dwordx4 v9, s[12:15], s45 offen offset:2048 lds
    v_mfma_f32_16x16x32_bf16 v[120:123], a[80:83], v[92:95], v[120:123]
    v_mfma_f32_16x16x32_bf16 v[120:123], a[104:107], v[96:99], v[120:123]
    s_mov_b64 exec, 0xfff
    buffer_load_dwordx4 v10, s[12:15], s45 offen offset:3072 lds
    s_mov_b64 exec, -1
    s_add_u32 s45, s45, 43008
    s_add_u32 s46, s46, 1
    v_mfma_f32_16x16x32_bf16 v[120:123], a[128:131], v[100:103], v[120:123]
    v_mfma_f32_16x16x32_bf16 v[120:123], a[152:155], v[32:35], v[120:123]
    v_mfma_f32_16x16x32_bf16 v[120:123], a[176:179], v[36:39], v[120:123]
    v_mfma_f32_16x16x32_bf16 v[120:123], a[200:203], v[40:43], v[120:123]
    v_cvt_pk_bf16_f32 v198, v116, v117
    v_mfma_f32_16x16x32_bf16 v[120:123], a[224:227], v[44:47], v[120:123]
    v_cvt_pk_bf16_f32 v199, v118, v119
    v_mfma_f32_16x16x32_bf16 v[120:123], a[248:251], v[48:51], v[120:123]
    buffer_store_dwordx4 v[196:199], v18, s[28:31], s57 offen sc1
    v_mfma_f32_16x16x32_bf16 v[120:123], v[228:231], v[52:55], v[120:123]
    v_mfma_f32_16x16x32_bf16 v[124:127], a[12:15], v[80:83], v[172:175]
    v_mfma_f32_16x16x32_bf16 v[124:127], a[36:39], v[84:87], v[124:127]
    v_mfma_f32_16x16x32_bf16 v[124:127], a[60:63], v[88:91], v[124:127]
    v_mfma_f32_16x16x32_bf16 v[124:127], a[84:87], v[92:95], v[124:127]
    v_mfma_f32_16x16x32_bf16 v[124:127], a[108:111], v[96:99], v[124:127]
    ds_read_b128 v[208:211], v31 offset:2048
    s_waitcnt vmcnt(9)
    v_mfma_f32_16x16x32_bf16 v[124:127], a[132:135], v[100:103], v[124:127]
    ds_read_b128 v[56:59], v14 offset:8192
    v_mfma_f32_16x16x32_bf16 v[124:127], a[156:159], v[32:35], v[124:127]
    ds_read_b128 v[60:63], v14 offset:8256
    v_mfma_f32_16x16x32_bf16 v[124:127], a[180:183], v[36:39], v[124:127]
    ds_read_b128 v[64:67], v14 offset:8320
    v_mfma_f32_16x16x32_bf16 v[124:127], a[204:207], v[40:43], v[124:127]
    v_mfma_f32_16x16x32_bf16 v[124:127], a[228:231], v[44:47], v[124:127]
    v_mfma_f32_16x16x32_bf16 v[124:127], a[252:255], v[48:51], v[124:127]
    s_waitcnt lgkmcnt(3)
    v_mfma_f32_16x16x32_bf16 v[124:127], v[232:235], v[52:55], v[124:127]
    buffer_store_dwordx4 v[208:211], v20, s[28:31], s92 offen offset:128 sc1
    v_mfma_f32_16x16x32_bf16 v[128:131], a[16:19], v[80:83], v[176:179]
    v_cvt_pk_bf16_f32 v184, v120, v121
    v_mfma_f32_16x16x32_bf16 v[128:131], a[40:43], v[84:87], v[128:131]
    v_cvt_pk_bf16_f32 v185, v122, v123
    v_mfma_f32_16x16x32_bf16 v[128:131], a[64:67], v[88:91], v[128:131]
    ds_read_b128 v[68:71], v15 offset:8192
    v_mfma_f32_16x16x32_bf16 v[128:131], a[88:91], v[92:95], v[128:131]
    ds_read_b128 v[72:75], v15 offset:8256
    v_mfma_f32_16x16x32_bf16 v[128:131], a[112:115], v[96:99], v[128:131]
    ds_read_b128 v[76:79], v15 offset:8320
    v_mfma_f32_16x16x32_bf16 v[128:131], a[136:139], v[100:103], v[128:131]
    v_mfma_f32_16x16x32_bf16 v[128:131], a[160:163], v[32:35], v[128:131]
    v_mfma_f32_16x16x32_bf16 v[128:131], a[184:187], v[36:39], v[128:131]
    v_mfma_f32_16x16x32_bf16 v[128:131], a[208:211], v[40:43], v[128:131]
    v_cvt_pk_bf16_f32 v186, v124, v125
    v_mfma_f32_16x16x32_bf16 v[128:131], a[232:235], v[44:47], v[128:131]
    v_cvt_pk_bf16_f32 v187, v126, v127
    v_mfma_f32_16x16x32_bf16 v[128:131], v[212:215], v[48:51], v[128:131]
    buffer_store_dwordx4 v[184:187], v18, s[28:31], s57 offen offset:64 sc1
    v_mfma_f32_16x16x32_bf16 v[128:131], v[236:239], v[52:55], v[128:131]
    v_mfma_f32_16x16x32_bf16 v[132:135], a[20:23], v[80:83], v[180:183]
    v_mfma_f32_16x16x32_bf16 v[132:135], a[44:47], v[84:87], v[132:135]
    v_mfma_f32_16x16x32_bf16 v[132:135], a[68:71], v[88:91], v[132:135]
    v_mfma_f32_16x16x32_bf16 v[132:135], a[92:95], v[92:95], v[132:135]
    v_mfma_f32_16x16x32_bf16 v[132:135], a[116:119], v[96:99], v[132:135]
    v_mfma_f32_16x16x32_bf16 v[132:135], a[140:143], v[100:103], v[132:135]
    v_mfma_f32_16x16x32_bf16 v[132:135], a[164:167], v[32:35], v[132:135]
    s_waitcnt lgkmcnt(0)
    v_mfma_f32_16x16x32_bf16 v[132:135], a[188:191], v[36:39], v[132:135]
    v_mfma_f32_16x16x32_bf16 v[132:135], a[212:215], v[40:43], v[132:135]
    v_mfma_f32_16x16x32_bf16 v[132:135], a[236:239], v[44:47], v[132:135]
    v_mfma_f32_16x16x32_bf16 v[132:135], v[216:219], v[48:51], v[132:135]
    v_mfma_f32_16x16x32_bf16 v[132:135], v[240:243], v[52:55], v[132:135]
    v_mfma_f32_16x16x32_bf16 v[136:139], a[0:3], v[32:35], v[160:163]
    v_cvt_pk_bf16_f32 v192, v128, v129
    v_mfma_f32_16x16x32_bf16 v[136:139], a[24:27], v[36:39], v[136:139]
    v_cvt_pk_bf16_f32 v193, v130, v131
    s_add_u32 s58, s57, 172032
    s_add_u32 m0, s47, 16384
    v_mfma_f32_16x16x32_bf16 v[136:139], a[48:51], v[40:43], v[136:139]
    buffer_load_dwordx4 v7, s[12:15], s45 offen lds
    v_mfma_f32_16x16x32_bf16 v[136:139], a[72:75], v[44:47], v[136:139]
    v_mfma_f32_16x16x32_bf16 v[136:139], a[96:99], v[48:51], v[136:139]
    buffer_load_dwordx4 v8, s[12:15], s45 offen offset:1024 lds
    v_mfma_f32_16x16x32_bf16 v[136:139], a[120:123], v[52:55], v[136:139]
    v_mfma_f32_16x16x32_bf16 v[136:139], a[144:147], v[56:59], v[136:139]
    v_mfma_f32_16x16x32_bf16 v[136:139], a[168:171], v[60:63], v[136:139]
    v_mfma_f32_16x16x32_bf16 v[136:139], a[192:195], v[64:67], v[136:139]
    v_cvt_pk_bf16_f32 v194, v132, v133
    v_mfma_f32_16x16x32_bf16 v[136:139], a[216:219], v[68:71], v[136:139]
    v_cvt_pk_bf16_f32 v195, v134, v135
    v_mfma_f32_16x16x32_bf16 v[136:139], a[240:243], v[72:75], v[136:139]
    buffer_store_dwordx4 v[192:195], v18, s[28:31], s57 offen offset:128 sc1
    v_mfma_f32_16x16x32_bf16 v[136:139], v[220:223], v[76:79], v[136:139]
    v_mfma_f32_16x16x32_bf16 v[152:155], a[4:7], v[32:35], v[164:167]
    v_mfma_f32_16x16x32_bf16 v[152:155], a[28:31], v[36:39], v[152:155]
    v_mfma_f32_16x16x32_bf16 v[152:155], a[52:55], v[40:43], v[152:155]
    v_mfma_f32_16x16x32_bf16 v[152:155], a[76:79], v[44:47], v[152:155]
    v_mfma_f32_16x16x32_bf16 v[152:155], a[100:103], v[48:51], v[152:155]
    v_mfma_f32_16x16x32_bf16 v[152:155], a[124:127], v[52:55], v[152:155]
    v_mfma_f32_16x16x32_bf16 v[152:155], a[148:151], v[56:59], v[152:155]
    v_mfma_f32_16x16x32_bf16 v[152:155], a[172:175], v[60:63], v[152:155]
    v_mfma_f32_16x16x32_bf16 v[152:155], a[196:199], v[64:67], v[152:155]
    v_mfma_f32_16x16x32_bf16 v[152:155], a[220:223], v[68:71], v[152:155]
    v_mfma_f32_16x16x32_bf16 v[152:155], a[244:247], v[72:75], v[152:155]
    v_mfma_f32_16x16x32_bf16 v[152:155], v[224:227], v[76:79], v[152:155]
    v_mfma_f32_16x16x32_bf16 v[140:143], a[8:11], v[32:35], v[168:171]
    v_cvt_pk_bf16_f32 v188, v136, v137
    v_mfma_f32_16x16x32_bf16 v[140:143], a[32:35], v[36:39], v[140:143]
    v_cvt_pk_bf16_f32 v189, v138, v139
    v_mfma_f32_16x16x32_bf16 v[140:143], a[56:59], v[40:43], v[140:143]
    buffer_load_dwordx4 v9, s[12:15], s45 offen offset:2048 lds
    v_mfma_f32_16x16x32_bf16 v[140:143], a[80:83], v[44:47], v[140:143]
    v_mfma_f32_16x16x32_bf16 v[140:143], a[104:107], v[48:51], v[140:143]
    s_mov_b64 exec, 0xfff
    buffer_load_dwordx4 v10, s[12:15], s45 offen offset:3072 lds
    s_mov_b64 exec, -1
    s_add_u32 s45, s45, 43008
    s_add_u32 s46, s46, 1
    v_mfma_f32_16x16x32_bf16 v[140:143], a[128:131], v[52:55], v[140:143]
    v_mfma_f32_16x16x32_bf16 v[140:143], a[152:155], v[56:59], v[140:143]
    v_mfma_f32_16x16x32_bf16 v[140:143], a[176:179], v[60:63], v[140:143]
    v_mfma_f32_16x16x32_bf16 v[140:143], a[200:203], v[64:67], v[140:143]
    v_cvt_pk_bf16_f32 v190, v152, v153
    v_mfma_f32_16x16x32_bf16 v[140:143], a[224:227], v[68:71], v[140:143]
    v_cvt_pk_bf16_f32 v191, v154, v155
    v_mfma_f32_16x16x32_bf16 v[140:143], a[248:251], v[72:75], v[140:143]
    buffer_store_dwordx4 v[188:191], v18, s[28:31], s58 offen sc1
    v_mfma_f32_16x16x32_bf16 v[140:143], v[228:231], v[76:79], v[140:143]
    v_mfma_f32_16x16x32_bf16 v[144:147], a[12:15], v[32:35], v[172:175]
    v_mfma_f32_16x16x32_bf16 v[144:147], a[36:39], v[36:39], v[144:147]
    v_mfma_f32_16x16x32_bf16 v[144:147], a[60:63], v[40:43], v[144:147]
    v_mfma_f32_16x16x32_bf16 v[144:147], a[84:87], v[44:47], v[144:147]
    v_mfma_f32_16x16x32_bf16 v[144:147], a[108:111], v[48:51], v[144:147]
    ds_read_b128 v[200:203], v31 offset:3072
    s_waitcnt vmcnt(9)
    v_mfma_f32_16x16x32_bf16 v[144:147], a[132:135], v[52:55], v[144:147]
    ds_read_b128 v[80:83], v14 offset:12288
    v_mfma_f32_16x16x32_bf16 v[144:147], a[156:159], v[56:59], v[144:147]
    ds_read_b128 v[84:87], v14 offset:12352
    v_mfma_f32_16x16x32_bf16 v[144:147], a[180:183], v[60:63], v[144:147]
    ds_read_b128 v[88:91], v14 offset:12416
    v_mfma_f32_16x16x32_bf16 v[144:147], a[204:207], v[64:67], v[144:147]
    v_mfma_f32_16x16x32_bf16 v[144:147], a[228:231], v[68:71], v[144:147]
    v_mfma_f32_16x16x32_bf16 v[144:147], a[252:255], v[72:75], v[144:147]
    s_waitcnt lgkmcnt(3)
    v_mfma_f32_16x16x32_bf16 v[144:147], v[232:235], v[76:79], v[144:147]
    buffer_store_dwordx4 v[200:203], v20, s[28:31], s93 offen sc1
    v_mfma_f32_16x16x32_bf16 v[148:151], a[16:19], v[32:35], v[176:179]
    v_cvt_pk_bf16_f32 v196, v140, v141
    v_mfma_f32_16x16x32_bf16 v[148:151], a[40:43], v[36:39], v[148:151]
    v_cvt_pk_bf16_f32 v197, v142, v143
    v_mfma_f32_16x16x32_bf16 v[148:151], a[64:67], v[40:43], v[148:151]
    ds_read_b128 v[92:95], v15 offset:12288
    v_mfma_f32_16x16x32_bf16 v[148:151], a[88:91], v[44:47], v[148:151]
    ds_read_b128 v[96:99], v15 offset:12352
    v_mfma_f32_16x16x32_bf16 v[148:151], a[112:115], v[48:51], v[148:151]
    ds_read_b128 v[100:103], v15 offset:12416
    v_mfma_f32_16x16x32_bf16 v[148:151], a[136:139], v[52:55], v[148:151]
    v_mfma_f32_16x16x32_bf16 v[148:151], a[160:163], v[56:59], v[148:151]
    v_mfma_f32_16x16x32_bf16 v[148:151], a[184:187], v[60:63], v[148:151]
    v_mfma_f32_16x16x32_bf16 v[148:151], a[208:211], v[64:67], v[148:151]
    v_cvt_pk_bf16_f32 v198, v144, v145
    v_mfma_f32_16x16x32_bf16 v[148:151], a[232:235], v[68:71], v[148:151]
    v_cvt_pk_bf16_f32 v199, v146, v147
    v_mfma_f32_16x16x32_bf16 v[148:151], v[212:215], v[72:75], v[148:151]
    buffer_store_dwordx4 v[196:199], v18, s[28:31], s58 offen offset:64 sc1
    v_mfma_f32_16x16x32_bf16 v[148:151], v[236:239], v[76:79], v[148:151]
    v_mfma_f32_16x16x32_bf16 v[156:159], a[20:23], v[32:35], v[180:183]
    v_mfma_f32_16x16x32_bf16 v[156:159], a[44:47], v[36:39], v[156:159]
    v_mfma_f32_16x16x32_bf16 v[156:159], a[68:71], v[40:43], v[156:159]
    v_mfma_f32_16x16x32_bf16 v[156:159], a[92:95], v[44:47], v[156:159]
    v_mfma_f32_16x16x32_bf16 v[156:159], a[116:119], v[48:51], v[156:159]
    v_mfma_f32_16x16x32_bf16 v[156:159], a[140:143], v[52:55], v[156:159]
    v_mfma_f32_16x16x32_bf16 v[156:159], a[164:167], v[56:59], v[156:159]
    s_waitcnt lgkmcnt(0)
    v_mfma_f32_16x16x32_bf16 v[156:159], a[188:191], v[60:63], v[156:159]
    v_mfma_f32_16x16x32_bf16 v[156:159], a[212:215], v[64:67], v[156:159]
    v_mfma_f32_16x16x32_bf16 v[156:159], a[236:239], v[68:71], v[156:159]
    v_mfma_f32_16x16x32_bf16 v[156:159], v[216:219], v[72:75], v[156:159]
    v_mfma_f32_16x16x32_bf16 v[156:159], v[240:243], v[76:79], v[156:159]
    v_mfma_f32_16x16x32_bf16 v[104:107], a[0:3], v[56:59], v[160:163]
    v_cvt_pk_bf16_f32 v184, v148, v149
    v_mfma_f32_16x16x32_bf16 v[104:107], a[24:27], v[60:63], v[104:107]
    v_cvt_pk_bf16_f32 v185, v150, v151
    s_add_u32 s59, s58, 172032
    s_add_u32 m0, s47, 0
    v_mfma_f32_16x16x32_bf16 v[104:107], a[48:51], v[64:67], v[104:107]
    buffer_load_dwordx4 v7, s[12:15], s45 offen lds
    v_mfma_f32_16x16x32_bf16 v[104:107], a[72:75], v[68:71], v[104:107]
    v_mfma_f32_16x16x32_bf16 v[104:107], a[96:99], v[72:75], v[104:107]
    buffer_load_dwordx4 v8, s[12:15], s45 offen offset:1024 lds
    v_mfma_f32_16x16x32_bf16 v[104:107], a[120:123], v[76:79], v[104:107]
    v_mfma_f32_16x16x32_bf16 v[104:107], a[144:147], v[80:83], v[104:107]
    v_mfma_f32_16x16x32_bf16 v[104:107], a[168:171], v[84:87], v[104:107]
    v_mfma_f32_16x16x32_bf16 v[104:107], a[192:195], v[88:91], v[104:107]
    v_cvt_pk_bf16_f32 v186, v156, v157
    v_mfma_f32_16x16x32_bf16 v[104:107], a[216:219], v[92:95], v[104:107]
    v_cvt_pk_bf16_f32 v187, v158, v159
    v_mfma_f32_16x16x32_bf16 v[104:107], a[240:243], v[96:99], v[104:107]
    buffer_store_dwordx4 v[184:187], v18, s[28:31], s58 offen offset:128 sc1
    v_mfma_f32_16x16x32_bf16 v[104:107], v[220:223], v[100:103], v[104:107]
    v_mfma_f32_16x16x32_bf16 v[108:111], a[4:7], v[56:59], v[164:167]
    v_mfma_f32_16x16x32_bf16 v[108:111], a[28:31], v[60:63], v[108:111]
    v_mfma_f32_16x16x32_bf16 v[108:111], a[52:55], v[64:67], v[108:111]
    v_mfma_f32_16x16x32_bf16 v[108:111], a[76:79], v[68:71], v[108:111]
    v_mfma_f32_16x16x32_bf16 v[108:111], a[100:103], v[72:75], v[108:111]
    v_mfma_f32_16x16x32_bf16 v[108:111], a[124:127], v[76:79], v[108:111]
    v_mfma_f32_16x16x32_bf16 v[108:111], a[148:151], v[80:83], v[108:111]
    v_mfma_f32_16x16x32_bf16 v[108:111], a[172:175], v[84:87], v[108:111]
    v_mfma_f32_16x16x32_bf16 v[108:111], a[196:199], v[88:91], v[108:111]
    v_mfma_f32_16x16x32_bf16 v[108:111], a[220:223], v[92:95], v[108:111]
    v_mfma_f32_16x16x32_bf16 v[108:111], a[244:247], v[96:99], v[108:111]
    v_mfma_f32_16x16x32_bf16 v[108:111], v[224:227], v[100:103], v[108:111]
    v_mfma_f32_16x16x32_bf16 v[112:115], a[8:11], v[56:59], v[168:171]
    v_cvt_pk_bf16_f32 v192, v104, v105
    v_mfma_f32_16x16x32_bf16 v[112:115], a[32:35], v[60:63], v[112:115]
    v_cvt_pk_bf16_f32 v193, v106, v107
    v_mfma_f32_16x16x32_bf16 v[112:115], a[56:59], v[64:67], v[112:115]
    buffer_load_dwordx4 v9, s[12:15], s45 offen offset:2048 lds
    v_mfma_f32_16x16x32_bf16 v[112:115], a[80:83], v[68:71], v[112:115]
    v_mfma_f32_16x16x32_bf16 v[112:115], a[104:107], v[72:75], v[112:115]
    s_mov_b64 exec, 0xfff
    buffer_load_dwordx4 v10, s[12:15], s45 offen offset:3072 lds
    s_mov_b64 exec, -1
    s_add_u32 s45, s45, 43008
    s_add_u32 s46, s46, 1
    v_mfma_f32_16x16x32_bf16 v[112:115], a[128:131], v[76:79], v[112:115]
    v_mfma_f32_16x16x32_bf16 v[112:115], a[152:155], v[80:83], v[112:115]
    v_mfma_f32_16x16x32_bf16 v[112:115], a[176:179], v[84:87], v[112:115]
    v_mfma_f32_16x16x32_bf16 v[112:115], a[200:203], v[88:91], v[112:115]
    v_cvt_pk_bf16_f32 v194, v108, v109
    v_mfma_f32_16x16x32_bf16 v[112:115], a[224:227], v[92:95], v[112:115]
    v_cvt_pk_bf16_f32 v195, v110, v111
    v_mfma_f32_16x16x32_bf16 v[112:115], a[248:251], v[96:99], v[112:115]
    buffer_store_dwordx4 v[192:195], v18, s[28:31], s59 offen sc1
    v_mfma_f32_16x16x32_bf16 v[112:115], v[228:231], v[100:103], v[112:115]
    v_mfma_f32_16x16x32_bf16 v[116:119], a[12:15], v[56:59], v[172:175]
    v_mfma_f32_16x16x32_bf16 v[116:119], a[36:39], v[60:63], v[116:119]
    v_mfma_f32_16x16x32_bf16 v[116:119], a[60:63], v[64:67], v[116:119]
    v_mfma_f32_16x16x32_bf16 v[116:119], a[84:87], v[68:71], v[116:119]
    v_mfma_f32_16x16x32_bf16 v[116:119], a[108:111], v[72:75], v[116:119]
    ds_read_b128 v[204:207], v31 offset:4096
    s_waitcnt vmcnt(9)
    v_mfma_f32_16x16x32_bf16 v[116:119], a[132:135], v[76:79], v[116:119]
    ds_read_b128 v[32:35], v14 offset:16384
    v_mfma_f32_16x16x32_bf16 v[116:119], a[156:159], v[80:83], v[116:119]
    ds_read_b128 v[36:39], v14 offset:16448
    v_mfma_f32_16x16x32_bf16 v[116:119], a[180:183], v[84:87], v[116:119]
    ds_read_b128 v[40:43], v14 offset:16512
    v_mfma_f32_16x16x32_bf16 v[116:119], a[204:207], v[88:91], v[116:119]
    v_mfma_f32_16x16x32_bf16 v[116:119], a[228:231], v[92:95], v[116:119]
    v_mfma_f32_16x16x32_bf16 v[116:119], a[252:255], v[96:99], v[116:119]
    s_waitcnt lgkmcnt(3)
    v_mfma_f32_16x16x32_bf16 v[116:119], v[232:235], v[100:103], v[116:119]
    buffer_store_dwordx4 v[204:207], v20, s[28:31], s93 offen offset:64 sc1
    v_mfma_f32_16x16x32_bf16 v[120:123], a[16:19], v[56:59], v[176:179]
    v_cvt_pk_bf16_f32 v188, v112, v113
    v_mfma_f32_16x16x32_bf16 v[120:123], a[40:43], v[60:63], v[120:123]
    v_cvt_pk_bf16_f32 v189, v114, v115
    v_mfma_f32_16x16x32_bf16 v[120:123], a[64:67], v[64:67], v[120:123]
    ds_read_b128 v[44:47], v15 offset:16384
    v_mfma_f32_16x16x32_bf16 v[120:123], a[88:91], v[68:71], v[120:123]
    ds_read_b128 v[48:51], v15 offset:16448
    v_mfma_f32_16x16x32_bf16 v[120:123], a[112:115], v[72:75], v[120:123]
    ds_read_b128 v[52:55], v15 offset:16512
    v_mfma_f32_16x16x32_bf16 v[120:123], a[136:139], v[76:79], v[120:123]
    v_mfma_f32_16x16x32_bf16 v[120:123], a[160:163], v[80:83], v[120:123]
    v_mfma_f32_16x16x32_bf16 v[120:123], a[184:187], v[84:87], v[120:123]
    v_mfma_f32_16x16x32_bf16 v[120:123], a[208:211], v[88:91], v[120:123]
    v_cvt_pk_bf16_f32 v190, v116, v117
    v_mfma_f32_16x16x32_bf16 v[120:123], a[232:235], v[92:95], v[120:123]
    v_cvt_pk_bf16_f32 v191, v118, v119
    v_mfma_f32_16x16x32_bf16 v[120:123], v[212:215], v[96:99], v[120:123]
    buffer_store_dwordx4 v[188:191], v18, s[28:31], s59 offen offset:64 sc1
    v_mfma_f32_16x16x32_bf16 v[120:123], v[236:239], v[100:103], v[120:123]
    v_mfma_f32_16x16x32_bf16 v[124:127], a[20:23], v[56:59], v[180:183]
    v_mfma_f32_16x16x32_bf16 v[124:127], a[44:47], v[60:63], v[124:127]
    v_mfma_f32_16x16x32_bf16 v[124:127], a[68:71], v[64:67], v[124:127]
    v_mfma_f32_16x16x32_bf16 v[124:127], a[92:95], v[68:71], v[124:127]
    v_mfma_f32_16x16x32_bf16 v[124:127], a[116:119], v[72:75], v[124:127]
    v_mfma_f32_16x16x32_bf16 v[124:127], a[140:143], v[76:79], v[124:127]
    v_mfma_f32_16x16x32_bf16 v[124:127], a[164:167], v[80:83], v[124:127]
    s_waitcnt lgkmcnt(0)
    v_mfma_f32_16x16x32_bf16 v[124:127], a[188:191], v[84:87], v[124:127]
    v_mfma_f32_16x16x32_bf16 v[124:127], a[212:215], v[88:91], v[124:127]
    v_mfma_f32_16x16x32_bf16 v[124:127], a[236:239], v[92:95], v[124:127]
    v_mfma_f32_16x16x32_bf16 v[124:127], v[216:219], v[96:99], v[124:127]
    v_mfma_f32_16x16x32_bf16 v[124:127], v[240:243], v[100:103], v[124:127]
    v_mfma_f32_16x16x32_bf16 v[128:131], a[0:3], v[80:83], v[160:163]
    v_cvt_pk_bf16_f32 v196, v120, v121
    v_mfma_f32_16x16x32_bf16 v[128:131], a[24:27], v[84:87], v[128:131]
    v_cvt_pk_bf16_f32 v197, v122, v123
    s_add_u32 s56, s59, 172032
    s_add_u32 m0, s47, 4096
    v_mfma_f32_16x16x32_bf16 v[128:131], a[48:51], v[88:91], v[128:131]
    buffer_load_dwordx4 v7, s[12:15], s45 offen lds
    v_mfma_f32_16x16x32_bf16 v[128:131], a[72:75], v[92:95], v[128:131]
    v_mfma_f32_16x16x32_bf16 v[128:131], a[96:99], v[96:99], v[128:131]
    buffer_load_dwordx4 v8, s[12:15], s45 offen offset:1024 lds
    v_mfma_f32_16x16x32_bf16 v[128:131], a[120:123], v[100:103], v[128:131]
    v_mfma_f32_16x16x32_bf16 v[128:131], a[144:147], v[32:35], v[128:131]
    v_mfma_f32_16x16x32_bf16 v[128:131], a[168:171], v[36:39], v[128:131]
    v_mfma_f32_16x16x32_bf16 v[128:131], a[192:195], v[40:43], v[128:131]
    v_cvt_pk_bf16_f32 v198, v124, v125
    v_mfma_f32_16x16x32_bf16 v[128:131], a[216:219], v[44:47], v[128:131]
    v_cvt_pk_bf16_f32 v199, v126, v127
    v_mfma_f32_16x16x32_bf16 v[128:131], a[240:243], v[48:51], v[128:131]
    buffer_store_dwordx4 v[196:199], v18, s[28:31], s59 offen offset:128 sc1
    v_mfma_f32_16x16x32_bf16 v[128:131], v[220:223], v[52:55], v[128:131]
    v_mfma_f32_16x16x32_bf16 v[132:135], a[4:7], v[80:83], v[164:167]
    v_mfma_f32_16x16x32_bf16 v[132:135], a[28:31], v[84:87], v[132:135]
    v_mfma_f32_16x16x32_bf16 v[132:135], a[52:55], v[88:91], v[132:135]
    v_mfma_f32_16x16x32_bf16 v[132:135], a[76:79], v[92:95], v[132:135]
    v_mfma_f32_16x16x32_bf16 v[132:135], a[100:103], v[96:99], v[132:135]
    v_mfma_f32_16x16x32_bf16 v[132:135], a[124:127], v[100:103], v[132:135]
    v_mfma_f32_16x16x32_bf16 v[132:135], a[148:151], v[32:35], v[132:135]
    v_mfma_f32_16x16x32_bf16 v[132:135], a[172:175], v[36:39], v[132:135]
    v_mfma_f32_16x16x32_bf16 v[132:135], a[196:199], v[40:43], v[132:135]
    v_mfma_f32_16x16x32_bf16 v[132:135], a[220:223], v[44:47], v[132:135]
    v_mfma_f32_16x16x32_bf16 v[132:135], a[244:247], v[48:51], v[132:135]
    v_mfma_f32_16x16x32_bf16 v[132:135], v[224:227], v[52:55], v[132:135]
    v_mfma_f32_16x16x32_bf16 v[136:139], a[8:11], v[80:83], v[168:171]
    v_cvt_pk_bf16_f32 v184, v128, v129
    v_mfma_f32_16x16x32_bf16 v[136:139], a[32:35], v[84:87], v[136:139]
    v_cvt_pk_bf16_f32 v185, v130, v131
    v_mfma_f32_16x16x32_bf16 v[136:139], a[56:59], v[88:91], v[136:139]
    buffer_load_dwordx4 v9, s[12:15], s45 offen offset:2048 lds
    v_mfma_f32_16x16x32_bf16 v[136:139], a[80:83], v[92:95], v[136:139]
    v_mfma_f32_16x16x32_bf16 v[136:139], a[104:107], v[96:99], v[136:139]
    s_mov_b64 exec, 0xfff
    buffer_load_dwordx4 v10, s[12:15], s45 offen offset:3072 lds
    s_mov_b64 exec, -1
    s_add_u32 s45, s45, 43008
    s_add_u32 s46, s46, 1
    v_mfma_f32_16x16x32_bf16 v[136:139], a[128:131], v[100:103], v[136:139]
    v_mfma_f32_16x16x32_bf16 v[136:139], a[152:155], v[32:35], v[136:139]
    v_mfma_f32_16x16x32_bf16 v[136:139], a[176:179], v[36:39], v[136:139]
    v_mfma_f32_16x16x32_bf16 v[136:139], a[200:203], v[40:43], v[136:139]
    v_cvt_pk_bf16_f32 v186, v132, v133
    v_mfma_f32_16x16x32_bf16 v[136:139], a[224:227], v[44:47], v[136:139]
    v_cvt_pk_bf16_f32 v187, v134, v135
    v_mfma_f32_16x16x32_bf16 v[136:139], a[248:251], v[48:51], v[136:139]
    buffer_store_dwordx4 v[184:187], v18, s[28:31], s56 offen sc1
    v_mfma_f32_16x16x32_bf16 v[136:139], v[228:231], v[52:55], v[136:139]
    v_mfma_f32_16x16x32_bf16 v[152:155], a[12:15], v[80:83], v[172:175]
    v_mfma_f32_16x16x32_bf16 v[152:155], a[36:39], v[84:87], v[152:155]
    v_mfma_f32_16x16x32_bf16 v[152:155], a[60:63], v[88:91], v[152:155]
    v_mfma_f32_16x16x32_bf16 v[152:155], a[84:87], v[92:95], v[152:155]
    v_mfma_f32_16x16x32_bf16 v[152:155], a[108:111], v[96:99], v[152:155]
    ds_read_b128 v[208:211], v31 offset:5120
    s_waitcnt vmcnt(9)
    v_mfma_f32_16x16x32_bf16 v[152:155], a[132:135], v[100:103], v[152:155]
    ds_read_b128 v[56:59], v14 offset:0
    v_mfma_f32_16x16x32_bf16 v[152:155], a[156:159], v[32:35], v[152:155]
    ds_read_b128 v[60:63], v14 offset:64
    v_mfma_f32_16x16x32_bf16 v[152:155], a[180:183], v[36:39], v[152:155]
    ds_read_b128 v[64:67], v14 offset:128
    v_mfma_f32_16x16x32_bf16 v[152:155], a[204:207], v[40:43], v[152:155]
    v_mfma_f32_16x16x32_bf16 v[152:155], a[228:231], v[44:47], v[152:155]
    v_mfma_f32_16x16x32_bf16 v[152:155], a[252:255], v[48:51], v[152:155]
    s_waitcnt lgkmcnt(3)
    v_mfma_f32_16x16x32_bf16 v[152:155], v[232:235], v[52:55], v[152:155]
    buffer_store_dwordx4 v[208:211], v20, s[28:31], s93 offen offset:128 sc1
    v_mfma_f32_16x16x32_bf16 v[140:143], a[16:19], v[80:83], v[176:179]
    v_cvt_pk_bf16_f32 v192, v136, v137
    v_mfma_f32_16x16x32_bf16 v[140:143], a[40:43], v[84:87], v[140:143]
    v_cvt_pk_bf16_f32 v193, v138, v139
    v_mfma_f32_16x16x32_bf16 v[140:143], a[64:67], v[88:91], v[140:143]
    ds_read_b128 v[68:71], v15 offset:0
    v_mfma_f32_16x16x32_bf16 v[140:143], a[88:91], v[92:95], v[140:143]
    ds_read_b128 v[72:75], v15 offset:64
    v_mfma_f32_16x16x32_bf16 v[140:143], a[112:115], v[96:99], v[140:143]
    ds_read_b128 v[76:79], v15 offset:128
    v_mfma_f32_16x16x32_bf16 v[140:143], a[136:139], v[100:103], v[140:143]
    v_mfma_f32_16x16x32_bf16 v[140:143], a[160:163], v[32:35], v[140:143]
    v_mfma_f32_16x16x32_bf16 v[140:143], a[184:187], v[36:39], v[140:143]
    v_mfma_f32_16x16x32_bf16 v[140:143], a[208:211], v[40:43], v[140:143]
    v_cvt_pk_bf16_f32 v194, v152, v153
    v_mfma_f32_16x16x32_bf16 v[140:143], a[232:235], v[44:47], v[140:143]
    v_cvt_pk_bf16_f32 v195, v154, v155
    v_mfma_f32_16x16x32_bf16 v[140:143], v[212:215], v[48:51], v[140:143]
    buffer_store_dwordx4 v[192:195], v18, s[28:31], s56 offen offset:64 sc1
    v_mfma_f32_16x16x32_bf16 v[140:143], v[236:239], v[52:55], v[140:143]
    v_mfma_f32_16x16x32_bf16 v[144:147], a[20:23], v[80:83], v[180:183]
    v_mfma_f32_16x16x32_bf16 v[144:147], a[44:47], v[84:87], v[144:147]
    v_mfma_f32_16x16x32_bf16 v[144:147], a[68:71], v[88:91], v[144:147]
    v_mfma_f32_16x16x32_bf16 v[144:147], a[92:95], v[92:95], v[144:147]
    v_mfma_f32_16x16x32_bf16 v[144:147], a[116:119], v[96:99], v[144:147]
    v_mfma_f32_16x16x32_bf16 v[144:147], a[140:143], v[100:103], v[144:147]
    v_mfma_f32_16x16x32_bf16 v[144:147], a[164:167], v[32:35], v[144:147]
    s_waitcnt lgkmcnt(0)
    v_mfma_f32_16x16x32_bf16 v[144:147], a[188:191], v[36:39], v[144:147]
    v_mfma_f32_16x16x32_bf16 v[144:147], a[212:215], v[40:43], v[144:147]
    v_mfma_f32_16x16x32_bf16 v[144:147], a[236:239], v[44:47], v[144:147]
    v_mfma_f32_16x16x32_bf16 v[144:147], v[216:219], v[48:51], v[144:147]
    v_mfma_f32_16x16x32_bf16 v[144:147], v[240:243], v[52:55], v[144:147]
    v_mfma_f32_16x16x32_bf16 v[148:151], a[0:3], v[32:35], v[160:163]
    v_cvt_pk_bf16_f32 v188, v140, v141
    v_mfma_f32_16x16x32_bf16 v[148:151], a[24:27], v[36:39], v[148:151]
    v_cvt_pk_bf16_f32 v189, v142, v143
    s_add_u32 s57, s56, 172032
    s_cmp_lt_u32 s46, 224
    s_cselect_b32 s18, 9633792, 0
    s_add_u32 m0, s47, 8192
    v_mfma_f32_16x16x32_bf16 v[148:151], a[48:51], v[40:43], v[148:151]
    buffer_load_dwordx4 v7, s[16:19], s45 offen lds
    v_mfma_f32_16x16x32_bf16 v[148:151], a[72:75], v[44:47], v[148:151]
    v_mfma_f32_16x16x32_bf16 v[148:151], a[96:99], v[48:51], v[148:151]
    buffer_load_dwordx4 v8, s[16:19], s45 offen offset:1024 lds
    v_mfma_f32_16x16x32_bf16 v[148:151], a[120:123], v[52:55], v[148:151]
    v_mfma_f32_16x16x32_bf16 v[148:151], a[144:147], v[56:59], v[148:151]
    v_mfma_f32_16x16x32_bf16 v[148:151], a[168:171], v[60:63], v[148:151]
    v_mfma_f32_16x16x32_bf16 v[148:151], a[192:195], v[64:67], v[148:151]
    v_cvt_pk_bf16_f32 v190, v144, v145
    v_mfma_f32_16x16x32_bf16 v[148:151], a[216:219], v[68:71], v[148:151]
    v_cvt_pk_bf16_f32 v191, v146, v147
    v_mfma_f32_16x16x32_bf16 v[148:151], a[240:243], v[72:75], v[148:151]
    buffer_store_dwordx4 v[188:191], v18, s[28:31], s56 offen offset:128 sc1
    v_mfma_f32_16x16x32_bf16 v[148:151], v[220:223], v[76:79], v[148:151]
    v_mfma_f32_16x16x32_bf16 v[156:159], a[4:7], v[32:35], v[164:167]
    v_mfma_f32_16x16x32_bf16 v[156:159], a[28:31], v[36:39], v[156:159]
    v_mfma_f32_16x16x32_bf16 v[156:159], a[52:55], v[40:43], v[156:159]
    v_mfma_f32_16x16x32_bf16 v[156:159], a[76:79], v[44:47], v[156:159]
    v_mfma_f32_16x16x32_bf16 v[156:159], a[100:103], v[48:51], v[156:159]
    v_mfma_f32_16x16x32_bf16 v[156:159], a[124:127], v[52:55], v[156:159]
    v_mfma_f32_16x16x32_bf16 v[156:159], a[148:151], v[56:59], v[156:159]
    v_mfma_f32_16x16x32_bf16 v[156:159], a[172:175], v[60:63], v[156:159]
    v_mfma_f32_16x16x32_bf16 v[156:159], a[196:199], v[64:67], v[156:159]
    v_mfma_f32_16x16x32_bf16 v[156:159], a[220:223], v[68:71], v[156:159]
    v_mfma_f32_16x16x32_bf16 v[156:159], a[244:247], v[72:75], v[156:159]
    v_mfma_f32_16x16x32_bf16 v[156:159], v[224:227], v[76:79], v[156:159]
    v_mfma_f32_16x16x32_bf16 v[104:107], a[8:11], v[32:35], v[168:171]
    v_cvt_pk_bf16_f32 v196, v148, v149
    v_mfma_f32_16x16x32_bf16 v[104:107], a[32:35], v[36:39], v[104:107]
    v_cvt_pk_bf16_f32 v197, v150, v151
    v_mfma_f32_16x16x32_bf16 v[104:107], a[56:59], v[40:43], v[104:107]
    buffer_load_dwordx4 v9, s[16:19], s45 offen offset:2048 lds
    v_mfma_f32_16x16x32_bf16 v[104:107], a[80:83], v[44:47], v[104:107]
    v_mfma_f32_16x16x32_bf16 v[104:107], a[104:107], v[48:51], v[104:107]
    s_mov_b64 exec, 0xfff
    buffer_load_dwordx4 v10, s[16:19], s45 offen offset:3072 lds
    s_mov_b64 exec, -1
    s_add_u32 s45, s45, 43008
    s_add_u32 s46, s46, 1
    v_mfma_f32_16x16x32_bf16 v[104:107], a[128:131], v[52:55], v[104:107]
    v_mfma_f32_16x16x32_bf16 v[104:107], a[152:155], v[56:59], v[104:107]
    v_mfma_f32_16x16x32_bf16 v[104:107], a[176:179], v[60:63], v[104:107]
    v_mfma_f32_16x16x32_bf16 v[104:107], a[200:203], v[64:67], v[104:107]
    v_cvt_pk_bf16_f32 v198, v156, v157
    v_mfma_f32_16x16x32_bf16 v[104:107], a[224:227], v[68:71], v[104:107]
    v_cvt_pk_bf16_f32 v199, v158, v159
    v_mfma_f32_16x16x32_bf16 v[104:107], a[248:251], v[72:75], v[104:107]
    buffer_store_dwordx4 v[196:199], v18, s[28:31], s57 offen sc1
    v_mfma_f32_16x16x32_bf16 v[104:107], v[228:231], v[76:79], v[104:107]
    v_mfma_f32_16x16x32_bf16 v[108:111], a[12:15], v[32:35], v[172:175]
    v_mfma_f32_16x16x32_bf16 v[108:111], a[36:39], v[36:39], v[108:111]
    v_mfma_f32_16x16x32_bf16 v[108:111], a[60:63], v[40:43], v[108:111]
    v_mfma_f32_16x16x32_bf16 v[108:111], a[84:87], v[44:47], v[108:111]
    v_mfma_f32_16x16x32_bf16 v[108:111], a[108:111], v[48:51], v[108:111]
    ds_read_b128 v[200:203], v31 offset:6144
    s_waitcnt vmcnt(9)
    v_mfma_f32_16x16x32_bf16 v[108:111], a[132:135], v[52:55], v[108:111]
    ds_read_b128 v[80:83], v14 offset:4096
    v_mfma_f32_16x16x32_bf16 v[108:111], a[156:159], v[56:59], v[108:111]
    ds_read_b128 v[84:87], v14 offset:4160
    v_mfma_f32_16x16x32_bf16 v[108:111], a[180:183], v[60:63], v[108:111]
    ds_read_b128 v[88:91], v14 offset:4224
    v_mfma_f32_16x16x32_bf16 v[108:111], a[204:207], v[64:67], v[108:111]
    v_mfma_f32_16x16x32_bf16 v[108:111], a[228:231], v[68:71], v[108:111]
    v_mfma_f32_16x16x32_bf16 v[108:111], a[252:255], v[72:75], v[108:111]
    s_waitcnt lgkmcnt(3)
    v_mfma_f32_16x16x32_bf16 v[108:111], v[232:235], v[76:79], v[108:111]
    buffer_store_dwordx4 v[200:203], v20, s[28:31], s94 offen sc1
    v_mfma_f32_16x16x32_bf16 v[112:115], a[16:19], v[32:35], v[176:179]
    v_cvt_pk_bf16_f32 v184, v104, v105
    v_mfma_f32_16x16x32_bf16 v[112:115], a[40:43], v[36:39], v[112:115]
    v_cvt_pk_bf16_f32 v185, v106, v107
    v_mfma_f32_16x16x32_bf16 v[112:115], a[64:67], v[40:43], v[112:115]
    ds_read_b128 v[92:95], v15 offset:4096
    v_mfma_f32_16x16x32_bf16 v[112:115], a[88:91], v[44:47], v[112:115]
    ds_read_b128 v[96:99], v15 offset:4160
    v_mfma_f32_16x16x32_bf16 v[112:115], a[112:115], v[48:51], v[112:115]
    ds_read_b128 v[100:103], v15 offset:4224
    v_mfma_f32_16x16x32_bf16 v[112:115], a[136:139], v[52:55], v[112:115]
    v_mfma_f32_16x16x32_bf16 v[112:115], a[160:163], v[56:59], v[112:115]
    v_mfma_f32_16x16x32_bf16 v[112:115], a[184:187], v[60:63], v[112:115]
    v_mfma_f32_16x16x32_bf16 v[112:115], a[208:211], v[64:67], v[112:115]
    v_cvt_pk_bf16_f32 v186, v108, v109
    v_mfma_f32_16x16x32_bf16 v[112:115], a[232:235], v[68:71], v[112:115]
    v_cvt_pk_bf16_f32 v187, v110, v111
    v_mfma_f32_16x16x32_bf16 v[112:115], v[212:215], v[72:75], v[112:115]
    buffer_store_dwordx4 v[184:187], v18, s[28:31], s57 offen offset:64 sc1
    v_mfma_f32_16x16x32_bf16 v[112:115], v[236:239], v[76:79], v[112:115]
    v_mfma_f32_16x16x32_bf16 v[116:119], a[20:23], v[32:35], v[180:183]
    v_mfma_f32_16x16x32_bf16 v[116:119], a[44:47], v[36:39], v[116:119]
    v_mfma_f32_16x16x32_bf16 v[116:119], a[68:71], v[40:43], v[116:119]
    v_mfma_f32_16x16x32_bf16 v[116:119], a[92:95], v[44:47], v[116:119]
    v_mfma_f32_16x16x32_bf16 v[116:119], a[116:119], v[48:51], v[116:119]
    v_mfma_f32_16x16x32_bf16 v[116:119], a[140:143], v[52:55], v[116:119]
    v_mfma_f32_16x16x32_bf16 v[116:119], a[164:167], v[56:59], v[116:119]
    s_waitcnt lgkmcnt(0)
    v_mfma_f32_16x16x32_bf16 v[116:119], a[188:191], v[60:63], v[116:119]
    v_mfma_f32_16x16x32_bf16 v[116:119], a[212:215], v[64:67], v[116:119]
    v_mfma_f32_16x16x32_bf16 v[116:119], a[236:239], v[68:71], v[116:119]
    v_mfma_f32_16x16x32_bf16 v[116:119], v[216:219], v[72:75], v[116:119]
    v_mfma_f32_16x16x32_bf16 v[116:119], v[240:243], v[76:79], v[116:119]
    v_mfma_f32_16x16x32_bf16 v[120:123], a[0:3], v[56:59], v[160:163]
    v_cvt_pk_bf16_f32 v192, v112, v113
    v_mfma_f32_16x16x32_bf16 v[120:123], a[24:27], v[60:63], v[120:123]
    v_cvt_pk_bf16_f32 v193, v114, v115
    s_add_u32 s58, s57, 172032
    s_cmp_lt_u32 s46, 224
    s_cselect_b32 s18, 9633792, 0
    s_add_u32 m0, s47, 12288
    v_mfma_f32_16x16x32_bf16 v[120:123], a[48:51], v[64:67], v[120:123]
    buffer_load_dwordx4 v7, s[16:19], s45 offen lds
    v_mfma_f32_16x16x32_bf16 v[120:123], a[72:75], v[68:71], v[120:123]
    v_mfma_f32_16x16x32_bf16 v[120:123], a[96:99], v[72:75], v[120:123]
    buffer_load_dwordx4 v8, s[16:19], s45 offen offset:1024 lds
    v_mfma_f32_16x16x32_bf16 v[120:123], a[120:123], v[76:79], v[120:123]
    v_mfma_f32_16x16x32_bf16 v[120:123], a[144:147], v[80:83], v[120:123]
    v_mfma_f32_16x16x32_bf16 v[120:123], a[168:171], v[84:87], v[120:123]
    v_mfma_f32_16x16x32_bf16 v[120:123], a[192:195], v[88:91], v[120:123]
    v_cvt_pk_bf16_f32 v194, v116, v117
    v_mfma_f32_16x16x32_bf16 v[120:123], a[216:219], v[92:95], v[120:123]
    v_cvt_pk_bf16_f32 v195, v118, v119
    v_mfma_f32_16x16x32_bf16 v[120:123], a[240:243], v[96:99], v[120:123]
    buffer_store_dwordx4 v[192:195], v18, s[28:31], s57 offen offset:128 sc1
    v_mfma_f32_16x16x32_bf16 v[120:123], v[220:223], v[100:103], v[120:123]
    v_mfma_f32_16x16x32_bf16 v[124:127], a[4:7], v[56:59], v[164:167]
    v_mfma_f32_16x16x32_bf16 v[124:127], a[28:31], v[60:63], v[124:127]
    v_mfma_f32_16x16x32_bf16 v[124:127], a[52:55], v[64:67], v[124:127]
    v_mfma_f32_16x16x32_bf16 v[124:127], a[76:79], v[68:71], v[124:127]
    v_mfma_f32_16x16x32_bf16 v[124:127], a[100:103], v[72:75], v[124:127]
    v_mfma_f32_16x16x32_bf16 v[124:127], a[124:127], v[76:79], v[124:127]
    v_mfma_f32_16x16x32_bf16 v[124:127], a[148:151], v[80:83], v[124:127]
    v_mfma_f32_16x16x32_bf16 v[124:127], a[172:175], v[84:87], v[124:127]
    v_mfma_f32_16x16x32_bf16 v[124:127], a[196:199], v[88:91], v[124:127]
    v_mfma_f32_16x16x32_bf16 v[124:127], a[220:223], v[92:95], v[124:127]
    v_mfma_f32_16x16x32_bf16 v[124:127], a[244:247], v[96:99], v[124:127]
    v_mfma_f32_16x16x32_bf16 v[124:127], v[224:227], v[100:103], v[124:127]
    v_mfma_f32_16x16x32_bf16 v[128:131], a[8:11], v[56:59], v[168:171]
    v_cvt_pk_bf16_f32 v188, v120, v121
    v_mfma_f32_16x16x32_bf16 v[128:131], a[32:35], v[60:63], v[128:131]
    v_cvt_pk_bf16_f32 v189, v122, v123
    v_mfma_f32_16x16x32_bf16 v[128:131], a[56:59], v[64:67], v[128:131]
    buffer_load_dwordx4 v9, s[16:19], s45 offen offset:2048 lds
    v_mfma_f32_16x16x32_bf16 v[128:131], a[80:83], v[68:71], v[128:131]
    v_mfma_f32_16x16x32_bf16 v[128:131], a[104:107], v[72:75], v[128:131]
    s_mov_b64 exec, 0xfff
    buffer_load_dwordx4 v10, s[16:19], s45 offen offset:3072 lds
    s_mov_b64 exec, -1
    s_add_u32 s45, s45, 43008
    s_add_u32 s46, s46, 1
    v_mfma_f32_16x16x32_bf16 v[128:131], a[128:131], v[76:79], v[128:131]
    v_mfma_f32_16x16x32_bf16 v[128:131], a[152:155], v[80:83], v[128:131]
    v_mfma_f32_16x16x32_bf16 v[128:131], a[176:179], v[84:87], v[128:131]
    v_mfma_f32_16x16x32_bf16 v[128:131], a[200:203], v[88:91], v[128:131]
    v_cvt_pk_bf16_f32 v190, v124, v125
    v_mfma_f32_16x16x32_bf16 v[128:131], a[224:227], v[92:95], v[128:131]
    v_cvt_pk_bf16_f32 v191, v126, v127
    v_mfma_f32_16x16x32_bf16 v[128:131], a[248:251], v[96:99], v[128:131]
    buffer_store_dwordx4 v[188:191], v18, s[28:31], s58 offen sc1
    v_mfma_f32_16x16x32_bf16 v[128:131], v[228:231], v[100:103], v[128:131]
    v_mfma_f32_16x16x32_bf16 v[132:135], a[12:15], v[56:59], v[172:175]
    v_mfma_f32_16x16x32_bf16 v[132:135], a[36:39], v[60:63], v[132:135]
    v_mfma_f32_16x16x32_bf16 v[132:135], a[60:63], v[64:67], v[132:135]
    v_mfma_f32_16x16x32_bf16 v[132:135], a[84:87], v[68:71], v[132:135]
    v_mfma_f32_16x16x32_bf16 v[132:135], a[108:111], v[72:75], v[132:135]
    ds_read_b128 v[204:207], v31 offset:7168
    s_waitcnt vmcnt(9)
    v_mfma_f32_16x16x32_bf16 v[132:135], a[132:135], v[76:79], v[132:135]
    ds_read_b128 v[32:35], v14 offset:8192
    v_mfma_f32_16x16x32_bf16 v[132:135], a[156:159], v[80:83], v[132:135]
    ds_read_b128 v[36:39], v14 offset:8256
    v_mfma_f32_16x16x32_bf16 v[132:135], a[180:183], v[84:87], v[132:135]
    ds_read_b128 v[40:43], v14 offset:8320
    v_mfma_f32_16x16x32_bf16 v[132:135], a[204:207], v[88:91], v[132:135]
    v_mfma_f32_16x16x32_bf16 v[132:135], a[228:231], v[92:95], v[132:135]
    v_mfma_f32_16x16x32_bf16 v[132:135], a[252:255], v[96:99], v[132:135]
    s_waitcnt lgkmcnt(3)
    v_mfma_f32_16x16x32_bf16 v[132:135], v[232:235], v[100:103], v[132:135]
    buffer_store_dwordx4 v[204:207], v20, s[28:31], s94 offen offset:64 sc1
    v_mfma_f32_16x16x32_bf16 v[136:139], a[16:19], v[56:59], v[176:179]
    v_cvt_pk_bf16_f32 v196, v128, v129
    v_mfma_f32_16x16x32_bf16 v[136:139], a[40:43], v[60:63], v[136:139]
    v_cvt_pk_bf16_f32 v197, v130, v131
    v_mfma_f32_16x16x32_bf16 v[136:139], a[64:67], v[64:67], v[136:139]
    ds_read_b128 v[44:47], v15 offset:8192
    v_mfma_f32_16x16x32_bf16 v[136:139], a[88:91], v[68:71], v[136:139]
    ds_read_b128 v[48:51], v15 offset:8256
    v_mfma_f32_16x16x32_bf16 v[136:139], a[112:115], v[72:75], v[136:139]
    ds_read_b128 v[52:55], v15 offset:8320
    v_mfma_f32_16x16x32_bf16 v[136:139], a[136:139], v[76:79], v[136:139]
    v_mfma_f32_16x16x32_bf16 v[136:139], a[160:163], v[80:83], v[136:139]
    v_mfma_f32_16x16x32_bf16 v[136:139], a[184:187], v[84:87], v[136:139]
    v_mfma_f32_16x16x32_bf16 v[136:139], a[208:211], v[88:91], v[136:139]
    v_cvt_pk_bf16_f32 v198, v132, v133
    v_mfma_f32_16x16x32_bf16 v[136:139], a[232:235], v[92:95], v[136:139]
    v_cvt_pk_bf16_f32 v199, v134, v135
    v_mfma_f32_16x16x32_bf16 v[136:139], v[212:215], v[96:99], v[136:139]
    buffer_store_dwordx4 v[196:199], v18, s[28:31], s58 offen offset:64 sc1
    v_mfma_f32_16x16x32_bf16 v[136:139], v[236:239], v[100:103], v[136:139]
    v_mfma_f32_16x16x32_bf16 v[152:155], a[20:23], v[56:59], v[180:183]
    v_mfma_f32_16x16x32_bf16 v[152:155], a[44:47], v[60:63], v[152:155]
    v_mfma_f32_16x16x32_bf16 v[152:155], a[68:71], v[64:67], v[152:155]
    v_mfma_f32_16x16x32_bf16 v[152:155], a[92:95], v[68:71], v[152:155]
    v_mfma_f32_16x16x32_bf16 v[152:155], a[116:119], v[72:75], v[152:155]
    v_mfma_f32_16x16x32_bf16 v[152:155], a[140:143], v[76:79], v[152:155]
    v_mfma_f32_16x16x32_bf16 v[152:155], a[164:167], v[80:83], v[152:155]
    s_waitcnt lgkmcnt(0)
    v_mfma_f32_16x16x32_bf16 v[152:155], a[188:191], v[84:87], v[152:155]
    v_mfma_f32_16x16x32_bf16 v[152:155], a[212:215], v[88:91], v[152:155]
    v_mfma_f32_16x16x32_bf16 v[152:155], a[236:239], v[92:95], v[152:155]
    v_mfma_f32_16x16x32_bf16 v[152:155], v[216:219], v[96:99], v[152:155]
    v_mfma_f32_16x16x32_bf16 v[152:155], v[240:243], v[100:103], v[152:155]
    v_mfma_f32_16x16x32_bf16 v[140:143], a[0:3], v[80:83], v[160:163]
    v_cvt_pk_bf16_f32 v184, v136, v137
    v_mfma_f32_16x16x32_bf16 v[140:143], a[24:27], v[84:87], v[140:143]
    v_cvt_pk_bf16_f32 v185, v138, v139
    s_add_u32 s59, s58, 172032
    v_mfma_f32_16x16x32_bf16 v[140:143], a[48:51], v[88:91], v[140:143]
    v_mfma_f32_16x16x32_bf16 v[140:143], a[72:75], v[92:95], v[140:143]
    v_mfma_f32_16x16x32_bf16 v[140:143], a[96:99], v[96:99], v[140:143]
    v_mfma_f32_16x16x32_bf16 v[140:143], a[120:123], v[100:103], v[140:143]
    v_mfma_f32_16x16x32_bf16 v[140:143], a[144:147], v[32:35], v[140:143]
    v_mfma_f32_16x16x32_bf16 v[140:143], a[168:171], v[36:39], v[140:143]
    v_mfma_f32_16x16x32_bf16 v[140:143], a[192:195], v[40:43], v[140:143]
    v_cvt_pk_bf16_f32 v186, v152, v153
    v_mfma_f32_16x16x32_bf16 v[140:143], a[216:219], v[44:47], v[140:143]
    v_cvt_pk_bf16_f32 v187, v154, v155
    v_mfma_f32_16x16x32_bf16 v[140:143], a[240:243], v[48:51], v[140:143]
    buffer_store_dwordx4 v[184:187], v18, s[28:31], s58 offen offset:128 sc1
    v_mfma_f32_16x16x32_bf16 v[140:143], v[220:223], v[52:55], v[140:143]
    v_mfma_f32_16x16x32_bf16 v[144:147], a[4:7], v[80:83], v[164:167]
    v_mfma_f32_16x16x32_bf16 v[144:147], a[28:31], v[84:87], v[144:147]
    v_mfma_f32_16x16x32_bf16 v[144:147], a[52:55], v[88:91], v[144:147]
    v_mfma_f32_16x16x32_bf16 v[144:147], a[76:79], v[92:95], v[144:147]
    v_mfma_f32_16x16x32_bf16 v[144:147], a[100:103], v[96:99], v[144:147]
    v_mfma_f32_16x16x32_bf16 v[144:147], a[124:127], v[100:103], v[144:147]
    v_mfma_f32_16x16x32_bf16 v[144:147], a[148:151], v[32:35], v[144:147]
    v_mfma_f32_16x16x32_bf16 v[144:147], a[172:175], v[36:39], v[144:147]
    v_mfma_f32_16x16x32_bf16 v[144:147], a[196:199], v[40:43], v[144:147]
    v_mfma_f32_16x16x32_bf16 v[144:147], a[220:223], v[44:47], v[144:147]
    v_mfma_f32_16x16x32_bf16 v[144:147], a[244:247], v[48:51], v[144:147]
    v_mfma_f32_16x16x32_bf16 v[144:147], v[224:227], v[52:55], v[144:147]
    v_mfma_f32_16x16x32_bf16 v[148:151], a[8:11], v[80:83], v[168:171]
    v_cvt_pk_bf16_f32 v192, v140, v141
    v_mfma_f32_16x16x32_bf16 v[148:151], a[32:35], v[84:87], v[148:151]
    v_cvt_pk_bf16_f32 v193, v142, v143
    v_mfma_f32_16x16x32_bf16 v[148:151], a[56:59], v[88:91], v[148:151]
    v_mfma_f32_16x16x32_bf16 v[148:151], a[80:83], v[92:95], v[148:151]
    v_mfma_f32_16x16x32_bf16 v[148:151], a[104:107], v[96:99], v[148:151]
    v_mfma_f32_16x16x32_bf16 v[148:151], a[128:131], v[100:103], v[148:151]
    v_mfma_f32_16x16x32_bf16 v[148:151], a[152:155], v[32:35], v[148:151]
    v_mfma_f32_16x16x32_bf16 v[148:151], a[176:179], v[36:39], v[148:151]
    v_mfma_f32_16x16x32_bf16 v[148:151], a[200:203], v[40:43], v[148:151]
    v_cvt_pk_bf16_f32 v194, v144, v145
    v_mfma_f32_16x16x32_bf16 v[148:151], a[224:227], v[44:47], v[148:151]
    v_cvt_pk_bf16_f32 v195, v146, v147
    v_mfma_f32_16x16x32_bf16 v[148:151], a[248:251], v[48:51], v[148:151]
    buffer_store_dwordx4 v[192:195], v18, s[28:31], s59 offen sc1
    v_mfma_f32_16x16x32_bf16 v[148:151], v[228:231], v[52:55], v[148:151]
    v_mfma_f32_16x16x32_bf16 v[156:159], a[12:15], v[80:83], v[172:175]
    v_mfma_f32_16x16x32_bf16 v[156:159], a[36:39], v[84:87], v[156:159]
    v_mfma_f32_16x16x32_bf16 v[156:159], a[60:63], v[88:91], v[156:159]
    v_mfma_f32_16x16x32_bf16 v[156:159], a[84:87], v[92:95], v[156:159]
    v_mfma_f32_16x16x32_bf16 v[156:159], a[108:111], v[96:99], v[156:159]
    ds_read_b128 v[208:211], v31 offset:8192
    s_waitcnt vmcnt(5)
    v_mfma_f32_16x16x32_bf16 v[156:159], a[132:135], v[100:103], v[156:159]
    ds_read_b128 v[56:59], v14 offset:12288
    v_mfma_f32_16x16x32_bf16 v[156:159], a[156:159], v[32:35], v[156:159]
    ds_read_b128 v[60:63], v14 offset:12352
    v_mfma_f32_16x16x32_bf16 v[156:159], a[180:183], v[36:39], v[156:159]
    ds_read_b128 v[64:67], v14 offset:12416
    v_mfma_f32_16x16x32_bf16 v[156:159], a[204:207], v[40:43], v[156:159]
    v_mfma_f32_16x16x32_bf16 v[156:159], a[228:231], v[44:47], v[156:159]
    v_mfma_f32_16x16x32_bf16 v[156:159], a[252:255], v[48:51], v[156:159]
    s_waitcnt lgkmcnt(3)
    v_mfma_f32_16x16x32_bf16 v[156:159], v[232:235], v[52:55], v[156:159]
    buffer_store_dwordx4 v[208:211], v20, s[28:31], s94 offen offset:128 sc1
    v_mfma_f32_16x16x32_bf16 v[104:107], a[16:19], v[80:83], v[176:179]
    v_cvt_pk_bf16_f32 v188, v148, v149
    v_mfma_f32_16x16x32_bf16 v[104:107], a[40:43], v[84:87], v[104:107]
    v_cvt_pk_bf16_f32 v189, v150, v151
    v_mfma_f32_16x16x32_bf16 v[104:107], a[64:67], v[88:91], v[104:107]
    ds_read_b128 v[68:71], v15 offset:12288
    v_mfma_f32_16x16x32_bf16 v[104:107], a[88:91], v[92:95], v[104:107]
    ds_read_b128 v[72:75], v15 offset:12352
    v_mfma_f32_16x16x32_bf16 v[104:107], a[112:115], v[96:99], v[104:107]
    ds_read_b128 v[76:79], v15 offset:12416
    v_mfma_f32_16x16x32_bf16 v[104:107], a[136:139], v[100:103], v[104:107]
    v_mfma_f32_16x16x32_bf16 v[104:107], a[160:163], v[32:35], v[104:107]
    v_mfma_f32_16x16x32_bf16 v[104:107], a[184:187], v[36:39], v[104:107]
    v_mfma_f32_16x16x32_bf16 v[104:107], a[208:211], v[40:43], v[104:107]
    v_cvt_pk_bf16_f32 v190, v156, v157
    v_mfma_f32_16x16x32_bf16 v[104:107], a[232:235], v[44:47], v[104:107]
    v_cvt_pk_bf16_f32 v191, v158, v159
    v_mfma_f32_16x16x32_bf16 v[104:107], v[212:215], v[48:51], v[104:107]
    buffer_store_dwordx4 v[188:191], v18, s[28:31], s59 offen offset:64 sc1
    v_mfma_f32_16x16x32_bf16 v[104:107], v[236:239], v[52:55], v[104:107]
    v_mfma_f32_16x16x32_bf16 v[108:111], a[20:23], v[80:83], v[180:183]
    v_mfma_f32_16x16x32_bf16 v[108:111], a[44:47], v[84:87], v[108:111]
    v_mfma_f32_16x16x32_bf16 v[108:111], a[68:71], v[88:91], v[108:111]
    v_mfma_f32_16x16x32_bf16 v[108:111], a[92:95], v[92:95], v[108:111]
    v_mfma_f32_16x16x32_bf16 v[108:111], a[116:119], v[96:99], v[108:111]
    v_mfma_f32_16x16x32_bf16 v[108:111], a[140:143], v[100:103], v[108:111]
    v_mfma_f32_16x16x32_bf16 v[108:111], a[164:167], v[32:35], v[108:111]
    s_waitcnt lgkmcnt(0)
    v_mfma_f32_16x16x32_bf16 v[108:111], a[188:191], v[36:39], v[108:111]
    v_mfma_f32_16x16x32_bf16 v[108:111], a[212:215], v[40:43], v[108:111]
    v_mfma_f32_16x16x32_bf16 v[108:111], a[236:239], v[44:47], v[108:111]
    v_mfma_f32_16x16x32_bf16 v[108:111], v[216:219], v[48:51], v[108:111]
    v_mfma_f32_16x16x32_bf16 v[108:111], v[240:243], v[52:55], v[108:111]
    s_cmp_eq_u32 s40, 12
    s_cbranch_scc1 L_tail12
    v_mfma_f32_16x16x32_bf16 v[112:115], a[0:3], v[32:35], v[160:163]
    v_cvt_pk_bf16_f32 v196, v104, v105
    v_mfma_f32_16x16x32_bf16 v[112:115], a[24:27], v[36:39], v[112:115]
    v_cvt_pk_bf16_f32 v197, v106, v107
    s_add_u32 s56, s59, 172032
    v_mfma_f32_16x16x32_bf16 v[112:115], a[48:51], v[40:43], v[112:115]
    v_mfma_f32_16x16x32_bf16 v[112:115], a[72:75], v[44:47], v[112:115]
    v_mfma_f32_16x16x32_bf16 v[112:115], a[96:99], v[48:51], v[112:115]
    v_mfma_f32_16x16x32_bf16 v[112:115], a[120:123], v[52:55], v[112:115]
    v_mfma_f32_16x16x32_bf16 v[112:115], a[144:147], v[56:59], v[112:115]
    v_mfma_f32_16x16x32_bf16 v[112:115], a[168:171], v[60:63], v[112:115]
    v_mfma_f32_16x16x32_bf16 v[112:115], a[192:195], v[64:67], v[112:115]
    v_cvt_pk_bf16_f32 v198, v108, v109
    v_mfma_f32_16x16x32_bf16 v[112:115], a[216:219], v[68:71], v[112:115]
    v_cvt_pk_bf16_f32 v199, v110, v111
    v_mfma_f32_16x16x32_bf16 v[112:115], a[240:243], v[72:75], v[112:115]
    buffer_store_dwordx4 v[196:199], v18, s[28:31], s59 offen offset:128 sc1
    v_mfma_f32_16x16x32_bf16 v[112:115], v[220:223], v[76:79], v[112:115]
    v_mfma_f32_16x16x32_bf16 v[116:119], a[4:7], v[32:35], v[164:167]
    v_mfma_f32_16x16x32_bf16 v[116:119], a[28:31], v[36:39], v[116:119]
    v_mfma_f32_16x16x32_bf16 v[116:119], a[52:55], v[40:43], v[116:119]
    v_mfma_f32_16x16x32_bf16 v[116:119], a[76:79], v[44:47], v[116:119]
    v_mfma_f32_16x16x32_bf16 v[116:119], a[100:103], v[48:51], v[116:119]
    v_mfma_f32_16x16x32_bf16 v[116:119], a[124:127], v[52:55], v[116:119]
    v_mfma_f32_16x16x32_bf16 v[116:119], a[148:151], v[56:59], v[116:119]
    v_mfma_f32_16x16x32_bf16 v[116:119], a[172:175], v[60:63], v[116:119]
    v_mfma_f32_16x16x32_bf16 v[116:119], a[196:199], v[64:67], v[116:119]
    v_mfma_f32_16x16x32_bf16 v[116:119], a[220:223], v[68:71], v[116:119]
    v_mfma_f32_16x16x32_bf16 v[116:119], a[244:247], v[72:75], v[116:119]
    v_mfma_f32_16x16x32_bf16 v[116:119], v[224:227], v[76:79], v[116:119]
    v_mfma_f32_16x16x32_bf16 v[120:123], a[8:11], v[32:35], v[168:171]
    v_cvt_pk_bf16_f32 v184, v112, v113
    v_mfma_f32_16x16x32_bf16 v[120:123], a[32:35], v[36:39], v[120:123]
    v_cvt_pk_bf16_f32 v185, v114, v115
    v_mfma_f32_16x16x32_bf16 v[120:123], a[56:59], v[40:43], v[120:123]
    v_mfma_f32_16x16x32_bf16 v[120:123], a[80:83], v[44:47], v[120:123]
    v_mfma_f32_16x16x32_bf16 v[120:123], a[104:107], v[48:51], v[120:123]
    v_mfma_f32_16x16x32_bf16 v[120:123], a[128:131], v[52:55], v[120:123]
    v_mfma_f32_16x16x32_bf16 v[120:123], a[152:155], v[56:59], v[120:123]
    v_mfma_f32_16x16x32_bf16 v[120:123], a[176:179], v[60:63], v[120:123]
    v_mfma_f32_16x16x32_bf16 v[120:123], a[200:203], v[64:67], v[120:123]
    v_cvt_pk_bf16_f32 v186, v116, v117
    v_mfma_f32_16x16x32_bf16 v[120:123], a[224:227], v[68:71], v[120:123]
    v_cvt_pk_bf16_f32 v187, v118, v119
    v_mfma_f32_16x16x32_bf16 v[120:123], a[248:251], v[72:75], v[120:123]
    buffer_store_dwordx4 v[184:187], v18, s[28:31], s56 offen sc1
    v_mfma_f32_16x16x32_bf16 v[120:123], v[228:231], v[76:79], v[120:123]
    v_mfma_f32_16x16x32_bf16 v[124:127], a[12:15], v[32:35], v[172:175]
    v_mfma_f32_16x16x32_bf16 v[124:127], a[36:39], v[36:39], v[124:127]
    v_mfma_f32_16x16x32_bf16 v[124:127], a[60:63], v[40:43], v[124:127]
    v_mfma_f32_16x16x32_bf16 v[124:127], a[84:87], v[44:47], v[124:127]
    v_mfma_f32_16x16x32_bf16 v[124:127], a[108:111], v[48:51], v[124:127]
    v_mfma_f32_16x16x32_bf16 v[124:127], a[132:135], v[52:55], v[124:127]
    v_mfma_f32_16x16x32_bf16 v[124:127], a[156:159], v[56:59], v[124:127]
    v_mfma_f32_16x16x32_bf16 v[124:127], a[180:183], v[60:63], v[124:127]
    v_mfma_f32_16x16x32_bf16 v[124:127], a[204:207], v[64:67], v[124:127]
    v_mfma_f32_16x16x32_bf16 v[124:127], a[228:231], v[68:71], v[124:127]
    v_mfma_f32_16x16x32_bf16 v[124:127], a[252:255], v[72:75], v[124:127]
    v_mfma_f32_16x16x32_bf16 v[124:127], v[232:235], v[76:79], v[124:127]
    v_mfma_f32_16x16x32_bf16 v[128:131], a[16:19], v[32:35], v[176:179]
    v_cvt_pk_bf16_f32 v192, v120, v121
    v_mfma_f32_16x16x32_bf16 v[128:131], a[40:43], v[36:39], v[128:131]
    v_cvt_pk_bf16_f32 v193, v122, v123
    v_mfma_f32_16x16x32_bf16 v[128:131], a[64:67], v[40:43], v[128:131]
    v_mfma_f32_16x16x32_bf16 v[128:131], a[88:91], v[44:47], v[128:131]
    v_mfma_f32_16x16x32_bf16 v[128:131], a[112:115], v[48:51], v[128:131]
    v_mfma_f32_16x16x32_bf16 v[128:131], a[136:139], v[52:55], v[128:131]
    v_mfma_f32_16x16x32_bf16 v[128:131], a[160:163], v[56:59], v[128:131]
    v_mfma_f32_16x16x32_bf16 v[128:131], a[184:187], v[60:63], v[128:131]
    v_mfma_f32_16x16x32_bf16 v[128:131], a[208:211], v[64:67], v[128:131]
    v_cvt_pk_bf16_f32 v194, v124, v125
    v_mfma_f32_16x16x32_bf16 v[128:131], a[232:235], v[68:71], v[128:131]
    v_cvt_pk_bf16_f32 v195, v126, v127
    v_mfma_f32_16x16x32_bf16 v[128:131], v[212:215], v[72:75], v[128:131]
    buffer_store_dwordx4 v[192:195], v18, s[28:31], s56 offen offset:64 sc1
    v_mfma_f32_16x16x32_bf16 v[128:131], v[236:239], v[76:79], v[128:131]
    v_mfma_f32_16x16x32_bf16 v[132:135], a[20:23], v[32:35], v[180:183]
    v_mfma_f32_16x16x32_bf16 v[132:135], a[44:47], v[36:39], v[132:135]
    v_mfma_f32_16x16x32_bf16 v[132:135], a[68:71], v[40:43], v[132:135]
    v_mfma_f32_16x16x32_bf16 v[132:135], a[92:95], v[44:47], v[132:135]
    v_mfma_f32_16x16x32_bf16 v[132:135], a[116:119], v[48:51], v[132:135]
    v_mfma_f32_16x16x32_bf16 v[132:135], a[140:143], v[52:55], v[132:135]
    v_mfma_f32_16x16x32_bf16 v[132:135], a[164:167], v[56:59], v[132:135]
    v_mfma_f32_16x16x32_bf16 v[132:135], a[188:191], v[60:63], v[132:135]
    v_mfma_f32_16x16x32_bf16 v[132:135], a[212:215], v[64:67], v[132:135]
    v_mfma_f32_16x16x32_bf16 v[132:135], a[236:239], v[68:71], v[132:135]
    v_mfma_f32_16x16x32_bf16 v[132:135], v[216:219], v[72:75], v[132:135]
    v_mfma_f32_16x16x32_bf16 v[132:135], v[240:243], v[76:79], v[132:135]
    s_nop 7
    v_cvt_pk_bf16_f32 v188, v128, v129
    v_cvt_pk_bf16_f32 v189, v130, v131
    v_cvt_pk_bf16_f32 v190, v132, v133
    v_cvt_pk_bf16_f32 v191, v134, v135
    buffer_store_dwordx4 v[188:191], v18, s[28:31], s56 offen offset:128 sc1
    s_endpgm
L_tail12:
    s_nop 7
    v_cvt_pk_bf16_f32 v196, v104, v105
    v_cvt_pk_bf16_f32 v197, v106, v107
    v_cvt_pk_bf16_f32 v198, v108, v109
    v_cvt_pk_bf16_f32 v199, v110, v111
    buffer_store_dwordx4 v[196:199], v18, s[28:31], s59 offen offset:128 sc1
L_end:
    s_endpgm
L_row2_alt:
    v_cvt_pk_bf16_f32 v184, v104, v105
    v_cvt_pk_bf16_f32 v185, v106, v107
    v_cvt_pk_bf16_f32 v186, v108, v109
    v_cvt_pk_bf16_f32 v187, v110, v111
    ds_write_b128 v30, v[184:187] offset:0
    v_cvt_pk_bf16_f32 v188, v112, v113
    v_cvt_pk_bf16_f32 v189, v114, v115
    v_cvt_pk_bf16_f32 v190, v116, v117
    v_cvt_pk_bf16_f32 v191, v118, v119
    ds_write_b128 v30, v[188:191] offset:1024
    v_cvt_pk_bf16_f32 v192, v120, v121
    v_cvt_pk_bf16_f32 v193, v122, v123
    v_cvt_pk_bf16_f32 v194, v124, v125
    v_cvt_pk_bf16_f32 v195, v126, v127
    ds_write_b128 v30, v[192:195] offset:2048
    v_cvt_pk_bf16_f32 v196, v128, v129
    v_cvt_pk_bf16_f32 v197, v130, v131
    v_cvt_pk_bf16_f32 v198, v132, v133
    v_cvt_pk_bf16_f32 v199, v134, v135
    ds_write_b128 v30, v[196:199] offset:3072
    v_cvt_pk_bf16_f32 v184, v136, v137
    v_cvt_pk_bf16_f32 v185, v138, v139
    v_cvt_pk_bf16_f32 v186, v140, v141
    v_cvt_pk_bf16_f32 v187, v142, v143
    ds_write_b128 v30, v[184:187] offset:4096
    v_cvt_pk_bf16_f32 v188, v144, v145
    v_cvt_pk_bf16_f32 v189, v146, v147
    v_cvt_pk_bf16_f32 v190, v148, v149
    v_cvt_pk_bf16_f32 v191, v150, v151
    ds_write_b128 v30, v[188:191] offset:5120
    v_mfma_f32_16x16x32_bf16 v[152:155], a[0:3], v[80:83], v[160:163]
    v_mfma_f32_16x16x32_bf16 v[152:155], a[24:27], v[84:87], v[152:155]
    s_add_u32 s58, s57, 172032
    v_mfma_f32_16x16x32_bf16 v[152:155], a[48:51], v[88:91], v[152:155]
    v_mfma_f32_16x16x32_bf16 v[152:155], a[72:75], v[92:95], v[152:155]
    v_mfma_f32_16x16x32_bf16 v[152:155], a[96:99], v[96:99], v[152:155]
    s_waitcnt lgkmcnt(6)
    v_mfma_f32_16x16x32_bf16 v[152:155], a[120:123], v[100:103], v[152:155]
    v_mfma_f32_16x16x32_bf16 v[152:155], a[144:147], v[32:35], v[152:155]
    v_mfma_f32_16x16x32_bf16 v[152:155], a[168:171], v[36:39], v[152:155]
    v_mfma_f32_16x16x32_bf16 v[152:155], a[192:195], v[40:43], v[152:155]
    v_mfma_f32_16x16x32_bf16 v[152:155], a[216:219], v[44:47], v[152:155]
    v_mfma_f32_16x16x32_bf16 v[152:155], a[240:243], v[48:51], v[152:155]
    v_mfma_f32_16x16x32_bf16 v[152:155], v[220:223], v[52:55], v[152:155]
    v_mfma_f32_16x16x32_bf16 v[156:159], a[4:7], v[80:83], v[164:167]
    v_mfma_f32_16x16x32_bf16 v[156:159], a[28:31], v[84:87], v[156:159]
    v_mfma_f32_16x16x32_bf16 v[156:159], a[52:55], v[88:91], v[156:159]
    v_mfma_f32_16x16x32_bf16 v[156:159], a[76:79], v[92:95], v[156:159]
    v_mfma_f32_16x16x32_bf16 v[156:159], a[100:103], v[96:99], v[156:159]
    v_mfma_f32_16x16x32_bf16 v[156:159], a[124:127], v[100:103], v[156:159]
    v_mfma_f32_16x16x32_bf16 v[156:159], a[148:151], v[32:35], v[156:159]
    v_mfma_f32_16x16x32_bf16 v[156:159], a[172:175], v[36:39], v[156:159]
    v_mfma_f32_16x16x32_bf16 v[156:159], a[196:199], v[40:43], v[156:159]
    v_mfma_f32_16x16x32_bf16 v[156:159], a[220:223], v[44:47], v[156:159]
    v_mfma_f32_16x16x32_bf16 v[156:159], a[244:247], v[48:51], v[156:159]
    v_mfma_f32_16x16x32_bf16 v[156:159], v[224:227], v[52:55], v[156:159]
    v_mfma_f32_16x16x32_bf16 v[104:107], a[8:11], v[80:83], v[168:171]
    v_cvt_pk_bf16_f32 v192, v152, v153
    v_mfma_f32_16x16x32_bf16 v[104:107], a[32:35], v[84:87], v[104:107]
    v_cvt_pk_bf16_f32 v193, v154, v155
    v_mfma_f32_16x16x32_bf16 v[104:107], a[56:59], v[88:91], v[104:107]
    v_mfma_f32_16x16x32_bf16 v[104:107], a[80:83], v[92:95], v[104:107]
    v_mfma_f32_16x16x32_bf16 v[104:107], a[104:107], v[96:99], v[104:107]
    v_mfma_f32_16x16x32_bf16 v[104:107], a[128:131], v[100:103], v[104:107]
    v_mfma_f32_16x16x32_bf16 v[104:107], a[152:155], v[32:35], v[104:107]
    v_mfma_f32_16x16x32_bf16 v[104:107], a[176:179], v[36:39], v[104:107]
    v_mfma_f32_16x16x32_bf16 v[104:107], a[200:203], v[40:43], v[104:107]
    v_cvt_pk_bf16_f32 v194, v156, v157
    v_mfma_f32_16x16x32_bf16 v[104:107], a[224:227], v[44:47], v[104:107]
    v_cvt_pk_bf16_f32 v195, v158, v159
    v_mfma_f32_16x16x32_bf16 v[104:107], a[248:251], v[48:51], v[104:107]
    ds_write_b128 v30, v[192:195] offset:6144
    v_mfma_f32_16x16x32_bf16 v[104:107], v[228:231], v[52:55], v[104:107]
    v_mfma_f32_16x16x32_bf16 v[108:111], a[12:15], v[80:83], v[172:175]
    v_mfma_f32_16x16x32_bf16 v[108:111], a[36:39], v[84:87], v[108:111]
    v_mfma_f32_16x16x32_bf16 v[108:111], a[60:63], v[88:91], v[108:111]
    v_mfma_f32_16x16x32_bf16 v[108:111], a[84:87], v[92:95], v[108:111]
    v_mfma_f32_16x16x32_bf16 v[108:111], a[108:111], v[96:99], v[108:111]
    s_waitcnt vmcnt(1)
    v_mfma_f32_16x16x32_bf16 v[108:111], a[132:135], v[100:103], v[108:111]
    ds_read_b128 v[56:59], v14 offset:16384
    v_mfma_f32_16x16x32_bf16 v[108:111], a[156:159], v[32:35], v[108:111]
    ds_read_b128 v[60:63], v14 offset:16448
    v_mfma_f32_16x16x32_bf16 v[108:111], a[180:183], v[36:39], v[108:111]
    ds_read_b128 v[64:67], v14 offset:16512
    v_mfma_f32_16x16x32_bf16 v[108:111], a[204:207], v[40:43], v[108:111]
    v_mfma_f32_16x16x32_bf16 v[108:111], a[228:231], v[44:47], v[108:111]
    v_mfma_f32_16x16x32_bf16 v[108:111], a[252:255], v[48:51], v[108:111]
    v_mfma_f32_16x16x32_bf16 v[108:111], v[232:235], v[52:55], v[108:111]
    v_mfma_f32_16x16x32_bf16 v[112:115], a[16:19], v[80:83], v[176:179]
    v_cvt_pk_bf16_f32 v196, v104, v105
    v_mfma_f32_16x16x32_bf16 v[112:115], a[40:43], v[84:87], v[112:115]
    s_add_u32 m0, s47, 0
    v_cvt_pk_bf16_f32 v197, v106, v107
    v_mfma_f32_16x16x32_bf16 v[112:115], a[64:67], v[88:91], v[112:115]
    buffer_load_dwordx4 v7, s[12:15], s45 offen lds
    ds_read_b128 v[68:71], v15 offset:16384
    v_mfma_f32_16x16x32_bf16 v[112:115], a[88:91], v[92:95], v[112:115]
    ds_read_b128 v[72:75], v15 offset:16448
    v_mfma_f32_16x16x32_bf16 v[112:115], a[112:115], v[96:99], v[112:115]
    ds_read_b128 v[76:79], v15 offset:16512
    v_mfma_f32_16x16x32_bf16 v[112:115], a[136:139], v[100:103], v[112:115]
    v_mfma_f32_16x16x32_bf16 v[112:115], a[160:163], v[32:35], v[112:115]
    v_mfma_f32_16x16x32_bf16 v[112:115], a[184:187], v[36:39], v[112:115]
    buffer_load_dwordx4 v8, s[12:15], s45 offen offset:1024 lds
    v_mfma_f32_16x16x32_bf16 v[112:115], a[208:211], v[40:43], v[112:115]
    v_cvt_pk_bf16_f32 v198, v108, v109
    v_mfma_f32_16x16x32_bf16 v[112:115], a[232:235], v[44:47], v[112:115]
    v_cvt_pk_bf16_f32 v199, v110, v111
    v_mfma_f32_16x16x32_bf16 v[112:115], v[212:215], v[48:51], v[112:115]
    ds_write_b128 v30, v[196:199] offset:7168
    v_mfma_f32_16x16x32_bf16 v[112:115], v[236:239], v[52:55], v[112:115]
    v_mfma_f32_16x16x32_bf16 v[116:119], a[20:23], v[80:83], v[180:183]
    buffer_load_dwordx4 v9, s[12:15], s45 offen offset:2048 lds
    v_mfma_f32_16x16x32_bf16 v[116:119], a[44:47], v[84:87], v[116:119]
    v_mfma_f32_16x16x32_bf16 v[116:119], a[68:71], v[88:91], v[116:119]
    v_mfma_f32_16x16x32_bf16 v[116:119], a[92:95], v[92:95], v[116:119]
    v_mfma_f32_16x16x32_bf16 v[116:119], a[116:119], v[96:99], v[116:119]
    v_mfma_f32_16x16x32_bf16 v[116:119], a[140:143], v[100:103], v[116:119]
    s_mov_b64 exec, 0xfff
    buffer_load_dwordx4 v10, s[12:15], s45 offen offset:3072 lds
    s_mov_b64 exec, -1
    s_add_u32 s45, s45, 43008
    s_add_u32 s46, s46, 1
    v_mfma_f32_16x16x32_bf16 v[116:119], a[164:167], v[32:35], v[116:119]
    s_waitcnt lgkmcnt(1)
    v_mfma_f32_16x16x32_bf16 v[116:119], a[188:191], v[36:39], v[116:119]
    v_mfma_f32_16x16x32_bf16 v[116:119], a[212:215], v[40:43], v[116:119]
    v_mfma_f32_16x16x32_bf16 v[116:119], a[236:239], v[44:47], v[116:119]
    v_mfma_f32_16x16x32_bf16 v[116:119], v[216:219], v[48:51], v[116:119]
    v_mfma_f32_16x16x32_bf16 v[116:119], v[240:243], v[52:55], v[116:119]
    s_branch L_row3
L_codeend:
.section .rodata,"a"
.p2align 6
.amdhsa_kernel standalone__transposed_strided__vision_kernel
  .amdhsa_next_free_vgpr 512
  .amdhsa_next_free_sgpr 100
  .amdhsa_accum_offset 256
  .amdhsa_group_segment_fixed_size 0
  .amdhsa_kernarg_size 48
  .amdhsa_user_sgpr_count 2
  .amdhsa_user_sgpr_kernarg_segment_ptr 1
  .amdhsa_system_sgpr_workgroup_id_x 1
.end_amdhsa_kernel
```
